```python
import torch

def _softmax(x, axis=-1):
    return torch.softmax(x, dim=axis)
def _gelu(x):
    return torch.nn.functional.gelu(x, approximate="tanh")
def _silu(x):
    return torch.nn.functional.silu(x)
def _sigmoid(x):
    return torch.sigmoid(x)
def _layernorm(x, axis=-1, eps=1e-5):
    m = x.mean(dim=axis, keepdim=True)
    v = x.var(dim=axis, keepdim=True, unbiased=False)
    return (x - m) / torch.sqrt(v + eps)
def _scatter_add(tgt, idx, src, axis=0):
    return tgt.clone().index_add_(axis, idx, src)
def _segment_sum(src, seg, n):
    out = torch.zeros((n,) + src.shape[1:], dtype=src.dtype)
    return out.index_add_(0, seg, src)
def _pad(x, pw):
    flat = tuple(v for pair in reversed(pw) for v in pair)
    return torch.nn.functional.pad(x, flat)

kernel_name = 'sequential_preLN__spectral_fnet__dense_activation_relu__prompt'

def setup_inputs():

    _w = (lambda a: (lambda t: t.to(torch.bfloat16) if t.is_floating_point() else t)(torch.as_tensor(a)))
    def _A_setup():
        B, S, D = 1, 2048, 512
        ns = torch.arange(S)[:, None] * torch.arange(S)[None, :]
        nd = torch.arange(D)[:, None] * torch.arange(D)[None, :]
        Ws_re = torch.cos(-2.0 * torch.pi * ns / S).to(float)
        Ws_im = torch.sin(-2.0 * torch.pi * ns / S).to(float)
        Wd_re = torch.cos(-2.0 * torch.pi * nd / D).to(float)
        Wd_im = torch.sin(-2.0 * torch.pi * nd / D).to(float)
        return {
            "x": _w((lambda *s: torch.randn(*s, dtype=torch.bfloat16) * 0.05)(B, S, D)),
            "dft_seq_re": _w(Ws_re),
            "dft_seq_im": _w(Ws_im),
            "dft_hid_re": _w(Wd_re),
            "dft_hid_im": _w(Wd_im),
        }
    _A_in = _A_setup()

    def _B_setup():
        B, S, D, Dff = 1, 2048, 512, 1792
        return {
            "x": _w((lambda *s: torch.randn(*s, dtype=torch.bfloat16) * 0.05)(B, S, D)),
            "w1": _w((lambda *s: torch.randn(*s, dtype=torch.bfloat16) * 0.4)(D, Dff)),
            "w2": _w((lambda *s: torch.randn(*s, dtype=torch.bfloat16) * 0.4)(Dff, D)),
        }
    _B_in = _B_setup()

    return {
        "A_x": _A_in["x"],
        "A_dft_seq_re": _A_in["dft_seq_re"],
        "A_dft_seq_im": _A_in["dft_seq_im"],
        "A_dft_hid_re": _A_in["dft_hid_re"],
        "A_dft_hid_im": _A_in["dft_hid_im"],
        "B_x": _B_in["x"],
        "B_w1": _B_in["w1"],
        "B_w2": _B_in["w2"],
    }

def reference(A_x, A_dft_seq_re, A_dft_seq_im, A_dft_hid_re, A_dft_hid_im, B_x, B_w1, B_w2):
    def _A_ref(x, dft_seq_re, dft_seq_im, dft_hid_re, dft_hid_im):
        a = torch.einsum("bsd,ed->bse", x, dft_hid_re)
        b = torch.einsum("bsd,ed->bse", x, dft_hid_im)
        y = torch.einsum("ts,bse->bte", dft_seq_re, a) - torch.einsum("ts,bse->bte", dft_seq_im, b)
        return y

    def _B_ref(x, w1, w2):
        h = torch.einsum("bsd,df->bsf", x, w1)
        zero = torch.zeros_like(h)
        h = torch.maximum(h, zero)
        return torch.einsum("bsf,fd->bsd", h, w2)

    x = A_x
    h = x + _A_ref(_layernorm(x, axis=-1), A_dft_seq_re, A_dft_seq_im, A_dft_hid_re, A_dft_hid_im)
    h2 = h + _B_ref(_layernorm(h, axis=-1), B_w1, B_w2)
    return h2
```

```asm
; @launch grid=(256,1,1) block=(512,1,1) lds=163840
.amdgcn_target "amdgcn-amd-amdhsa--gfx950"
.text
.globl sequential_preLN__spectral_fnet__dense_activation_relu__prompt_kernel
.p2align 8
.type sequential_preLN__spectral_fnet__dense_activation_relu__prompt_kernel,@function
sequential_preLN__spectral_fnet__dense_activation_relu__prompt_kernel:
    s_cmp_ge_u32 s2, 256
    s_cbranch_scc1 L_end
    s_load_dwordx16 s[44:59], s[0:1], 0
    s_load_dwordx4 s[60:63], s[0:1], 64
    s_load_dwordx2 s[96:97], s[0:1], 80
    v_lshrrev_b32 v4, 6, v0
    v_and_b32 v0, 63, v0
    v_lshrrev_b32 v1, 4, v0
    v_readfirstlane_b32 s79, v4
    v_and_b32 v2, 15, v0
    v_lshlrev_b32 v3, 4, v0
    s_and_b32 s3, s79, 3
    s_and_b32 s76, s2, 7
    s_lshr_b32 s77, s2, 3
    s_lshl_b32 s6, s76, 3
    s_and_b32 s78, s77, 7
    s_add_u32 s6, s6, s78
    s_lshr_b32 s7, s77, 3
    s_lshl_b32 s87, s3, 13
    s_cmp_ge_u32 s79, 4
    s_cbranch_scc1 L_helper
    s_and_b32 s76, s3, 1
    s_lshl_b32 s77, s76, 2
    s_lshr_b32 s78, s3, 1
    s_add_u32 s77, s77, s78
    s_lshl_b32 s78, s6, 3
    s_add_u32 s85, s77, s78
    s_lshl_b32 s86, s76, 7
    v_xor_b32 v13, s86, v3
    s_waitcnt lgkmcnt(0)
    s_mov_b32 s12, s44
    s_mov_b32 s13, s45
    s_mov_b32 s14, 2097152
    s_mov_b32 s15, 0x20000
    s_add_u32 s76, s85, 0
    s_lshl_b32 s76, s76, 10
    s_add_u32 m0, s87, 0
    v_xor_b32 v4, 0, v13
    buffer_load_dwordx4 v4, s[12:15], s76 offen lds
    s_sub_u32 s76, 2048, s85
    s_cmp_eq_u32 s85, 0
    s_cselect_b32 s76, 512, s76
    s_lshl_b32 s76, s76, 10
    s_add_u32 m0, s87, 1024
    v_xor_b32 v4, 16, v13
    buffer_load_dwordx4 v4, s[12:15], s76 offen lds
    s_add_u32 s76, s85, 1024
    s_lshl_b32 s76, s76, 10
    s_add_u32 m0, s87, 2048
    v_xor_b32 v4, 32, v13
    buffer_load_dwordx4 v4, s[12:15], s76 offen lds
    s_sub_u32 s76, 1024, s85
    s_cmp_eq_u32 s85, 0
    s_cselect_b32 s76, 1536, s76
    s_lshl_b32 s76, s76, 10
    s_add_u32 m0, s87, 3072
    v_xor_b32 v4, 48, v13
    buffer_load_dwordx4 v4, s[12:15], s76 offen lds
    s_add_u32 s76, s85, 2
    s_lshl_b32 s76, s76, 10
    s_add_u32 m0, s87, 4096
    v_xor_b32 v4, 64, v13
    buffer_load_dwordx4 v4, s[12:15], s76 offen lds
    s_sub_u32 s76, 2046, s85
    s_lshl_b32 s76, s76, 10
    s_add_u32 m0, s87, 5120
    v_xor_b32 v4, 80, v13
    buffer_load_dwordx4 v4, s[12:15], s76 offen lds
    s_add_u32 s76, s85, 1026
    s_lshl_b32 s76, s76, 10
    s_add_u32 m0, s87, 6144
    v_xor_b32 v4, 96, v13
    buffer_load_dwordx4 v4, s[12:15], s76 offen lds
    s_sub_u32 s76, 1022, s85
    s_lshl_b32 s76, s76, 10
    s_add_u32 m0, s87, 7168
    v_xor_b32 v4, 112, v13
    buffer_load_dwordx4 v4, s[12:15], s76 offen lds
    s_and_b32 s76, s2, 7
    s_lshr_b32 s77, s2, 3
    s_and_b32 s78, s77, 1
    s_lshl_b32 s4, s76, 1
    s_add_u32 s4, s4, s78
    s_lshr_b32 s5, s77, 1
    s_and_b32 s78, s5, 1
    s_lshl_b32 s8, s4, 1
    s_add_u32 s8, s8, s78
    s_lshr_b32 s9, s5, 1
    s_lshr_b32 s10, s8, 4
    s_and_b32 s11, s8, 15
    s_mov_b32 s80, 4096
    s_mov_b32 s81, 8192
    s_mov_b32 s82, 12288
    s_mov_b32 s83, 0x3f803f80
    s_mov_b32 s84, 0xffff0000
    s_mov_b32 s92, -1
    s_mov_b32 s93, 0x00ffffff
    s_and_b32 s98, s4, 14
    s_mul_i32 s98, s98, 1
    s_bfe_u32 s76, s4, 0x10001
    s_mul_i32 s99, s76, 7
    s_mov_b32 s68, s62
    s_mov_b32 s69, s63
    s_mov_b32 s70, 256
    s_mov_b32 s71, 0x20000
    s_cmp_eq_u32 s10, 0
    s_cselect_b32 s72, s46, s48
    s_cselect_b32 s73, s47, s49
    s_mov_b32 s74, 8388608
    s_mov_b32 s75, 0x20000
    s_mov_b32 s40, s60
    s_mov_b32 s41, s61
    s_mov_b32 s42, 2097152
    s_mov_b32 s43, 0x20000
    s_mov_b32 s36, s58
    s_mov_b32 s37, s59
    s_mov_b32 s38, 1835008
    s_mov_b32 s39, 0x20000
    s_mov_b32 s32, s56
    s_mov_b32 s33, s57
    s_mov_b32 s34, 1835008
    s_mov_b32 s35, 0x20000
    s_mov_b32 s20, s48
    s_mov_b32 s21, s49
    s_mov_b32 s22, 8388608
    s_mov_b32 s23, 0x20000
    s_mov_b32 s16, s46
    s_mov_b32 s17, s47
    s_mov_b32 s18, 8388608
    s_mov_b32 s19, 0x20000
    s_mov_b32 s12, s44
    s_mov_b32 s13, s45
    s_mov_b32 s14, 2097152
    s_mov_b32 s15, 0x20000
    s_add_u32 s52, s96, 1114112
    s_addc_u32 s53, s97, 0
    s_mov_b32 s54, 32768
    s_mov_b32 s55, 0x20000
    s_mov_b32 s44, s96
    s_mov_b32 s45, s97
    s_mov_b32 s46, 1048576
    s_mov_b32 s47, 0x20000
    s_add_u32 s48, s96, 1048576
    s_addc_u32 s49, s97, 0
    s_mov_b32 s50, 2048
    s_mov_b32 s51, 0x20000
    s_add_u32 s56, s96, 1703936
    s_addc_u32 s57, s97, 0
    s_mov_b32 s58, 262144
    s_mov_b32 s59, 0x20000
    s_add_u32 s60, s96, 2097152
    s_addc_u32 s61, s97, 0
    s_mov_b32 s62, 2097152
    s_mov_b32 s63, 0x20000
    s_add_u32 s64, s96, 4194304
    s_addc_u32 s65, s97, 0
    s_mov_b32 s66, 7340032
    s_mov_b32 s67, 0x20000
    s_lshr_b32 s85, s3, 1
    s_and_b32 s86, s3, 1
    s_lshl_b32 s76, s11, 6
    s_add_u32 s76, s76, s10
    s_lshl_b32 s77, s85, 5
    s_add_u32 s76, s76, s77
    v_lshl_add_u32 v26, v2, 1, s76
    v_cmp_eq_u32 vcc, 0, v26
    s_lshl_b32 s76, s9, 6
    s_lshl_b32 s77, s86, 5
    s_add_u32 s76, s76, s77
    v_lshl_add_u32 v28, v1, 3, s76
    v_lshlrev_b32 v6, 12, v26
    v_mov_b32 v7, 4194304
    v_cndmask_b32 v7, v6, v7, vcc
    buffer_load_ushort v24, v6, s[72:75], 0 offen offset:1024
    buffer_load_ushort v25, v7, s[72:75], 0 offen offset:1024
    s_lshl_b32 s76, s7, 2
    s_and_b32 s77, s6, 3
    s_add_u32 s76, s76, s77
    s_lshl_b32 s76, s76, 10
    v_lshl_add_u32 v29, v0, 8, s76
    s_lshr_b32 s76, s9, 1
    s_lshl_b32 s76, s76, 12
    s_and_b32 s77, s8, 3
    s_lshl_b32 s77, s77, 8
    s_add_u32 s76, s76, s77
    v_lshl_add_u32 v30, v0, 10, s76
    s_lshl_b32 s76, s4, 8
    s_add_u32 s76, s76, 16384
    v_mov_b32 v31, s76
    v_mov_b32 v14, 163584
    v_mov_b32 v15, 1
    v_lshrrev_b32 v4, 2, v2
    v_xor_b32 v4, s3, v4
    v_and_b32 v5, 3, v2
    v_xor_b32 v5, v5, v1
    v_lshlrev_b32 v5, 4, v5
    s_add_u32 s76, s87, 32768
    v_xor_b32 v6, 0, v4
    v_lshl_add_u32 v6, v6, 6, v5
    v_lshl_add_u32 v16, v2, 10, v6
    v_lshl_add_u32 v6, v2, 8, v6
    v_add_u32 v20, s76, v6
    v_xor_b32 v6, 1, v4
    v_lshl_add_u32 v6, v6, 6, v5
    v_lshl_add_u32 v17, v2, 10, v6
    v_lshl_add_u32 v6, v2, 8, v6
    v_add_u32 v21, s76, v6
    v_xor_b32 v6, 2, v4
    v_lshl_add_u32 v6, v6, 6, v5
    v_lshl_add_u32 v18, v2, 10, v6
    v_lshl_add_u32 v6, v2, 8, v6
    v_add_u32 v22, s76, v6
    v_xor_b32 v6, 3, v4
    v_lshl_add_u32 v6, v6, 6, v5
    v_lshl_add_u32 v19, v2, 10, v6
    v_lshl_add_u32 v6, v2, 8, v6
    v_add_u32 v23, s76, v6
    v_mov_b32 v216, s83
    v_mov_b32 v217, s83
    v_mov_b32 v218, s83
    v_mov_b32 v219, s83
    v_and_b32 v4, 1, v2
    v_lshlrev_b32 v5, 31, v4
    v_or_b32 v200, 1.0, v5
    v_and_b32 v5, 2, v2
    v_lshlrev_b32 v5, 30, v5
    v_or_b32 v5, 1.0, v5
    v_cmp_eq_u32 vcc, 0, v4
    v_mov_b32 v201, v200
    v_and_b32 v6, 3, v2
    v_cndmask_b32 v202, 0, v5, vcc
    v_cndmask_b32 v204, v5, 0, vcc
    v_cmp_eq_u32 vcc, 0, v6
    v_mov_b32 v203, v202
    v_mov_b32 v205, v204
    v_cndmask_b32 v206, 0, 4.0, vcc
    v_lshlrev_b32 v9, 4, v1
    v_add_u32 v9, 65536, v9
    s_lshl_b32 s76, s7, 2
    s_add_u32 s76, s76, s3
    s_lshl_b32 s76, s76, 14
    s_lshl_b32 s77, s6, 8
    s_add_u32 s76, s76, s77
    v_lshl_add_u32 v12, v2, 4, s76
    v_lshl_add_u32 v12, v1, 18, v12
    v_or_b32 v13, s6, v1
    v_cmp_eq_u32 s[94:95], 0, v13
    v_mov_b32 v220, 0x3b000000
    v_mov_b32 v221, 0x3b000000
    v_mov_b32 v222, 0x3727c5ac
    v_mov_b32 v223, 0x3727c5ac
    s_waitcnt vmcnt(2)
    s_barrier
    ds_read_b128 v[32:35], v20 offset:0
    ds_read_b128 v[36:39], v21 offset:0
    ds_read_b128 v[40:43], v22 offset:0
    ds_read_b128 v[44:47], v23 offset:0
    ds_read_b128 v[48:51], v20 offset:4096
    ds_read_b128 v[52:55], v21 offset:4096
    ds_read_b128 v[56:59], v22 offset:4096
    ds_read_b128 v[60:63], v23 offset:4096
    ds_read_b128 v[64:67], v16 offset:0
    ds_read_b128 v[68:71], v16 offset:16384
    ds_read_b128 v[72:75], v16 offset:256
    ds_read_b128 v[76:79], v16 offset:16640
    ds_read_b128 v[80:83], v16 offset:512
    ds_read_b128 v[84:87], v16 offset:16896
    ds_read_b128 v[88:91], v16 offset:768
    ds_read_b128 v[92:95], v16 offset:17152
    s_waitcnt lgkmcnt(0)
    ds_read_b128 v[96:99], v17 offset:0
    ds_read_b128 v[100:103], v17 offset:16384
    ds_read_b128 v[104:107], v17 offset:256
    ds_read_b128 v[108:111], v17 offset:16640
    ds_read_b128 v[112:115], v17 offset:512
    ds_read_b128 v[116:119], v17 offset:16896
    ds_read_b128 v[120:123], v17 offset:768
    ds_read_b128 v[124:127], v17 offset:17152
    v_mfma_f32_16x16x32_bf16 v[192:195], v[216:219], v[32:35], 0
    v_mfma_f32_16x16x32_bf16 v[196:199], v[216:219], v[48:51], 0
    v_mfma_f32_16x16x32_bf16 v[128:131], v[64:67], v[32:35], 0
    v_mfma_f32_16x16x32_bf16 v[132:135], v[64:67], v[48:51], 0
    v_mfma_f32_16x16x32_bf16 v[136:139], v[68:71], v[32:35], 0
    v_mfma_f32_16x16x32_bf16 v[140:143], v[68:71], v[48:51], 0
    v_mfma_f32_16x16x32_bf16 v[144:147], v[72:75], v[32:35], 0
    v_mfma_f32_16x16x32_bf16 v[148:151], v[72:75], v[48:51], 0
    v_mfma_f32_16x16x32_bf16 v[152:155], v[76:79], v[32:35], 0
    v_mfma_f32_16x16x32_bf16 v[156:159], v[76:79], v[48:51], 0
    v_mfma_f32_16x16x32_bf16 v[160:163], v[80:83], v[32:35], 0
    v_mfma_f32_16x16x32_bf16 v[164:167], v[80:83], v[48:51], 0
    v_mfma_f32_16x16x32_bf16 v[168:171], v[84:87], v[32:35], 0
    v_mfma_f32_16x16x32_bf16 v[172:175], v[84:87], v[48:51], 0
    v_mfma_f32_16x16x32_bf16 v[176:179], v[88:91], v[32:35], 0
    v_mfma_f32_16x16x32_bf16 v[180:183], v[88:91], v[48:51], 0
    v_mfma_f32_16x16x32_bf16 v[184:187], v[92:95], v[32:35], 0
    v_mfma_f32_16x16x32_bf16 v[188:191], v[92:95], v[48:51], 0
    s_waitcnt lgkmcnt(0)
    ds_read_b128 v[64:67], v18 offset:0
    ds_read_b128 v[68:71], v18 offset:16384
    ds_read_b128 v[72:75], v18 offset:256
    ds_read_b128 v[76:79], v18 offset:16640
    ds_read_b128 v[80:83], v18 offset:512
    ds_read_b128 v[84:87], v18 offset:16896
    ds_read_b128 v[88:91], v18 offset:768
    ds_read_b128 v[92:95], v18 offset:17152
    v_mfma_f32_16x16x32_bf16 v[192:195], v[216:219], v[36:39], v[192:195]
    v_mfma_f32_16x16x32_bf16 v[196:199], v[216:219], v[52:55], v[196:199]
    v_mfma_f32_16x16x32_bf16 v[128:131], v[96:99], v[36:39], v[128:131]
    v_mfma_f32_16x16x32_bf16 v[132:135], v[96:99], v[52:55], v[132:135]
    v_mfma_f32_16x16x32_bf16 v[136:139], v[100:103], v[36:39], v[136:139]
    v_mfma_f32_16x16x32_bf16 v[140:143], v[100:103], v[52:55], v[140:143]
    v_mfma_f32_16x16x32_bf16 v[144:147], v[104:107], v[36:39], v[144:147]
    v_mfma_f32_16x16x32_bf16 v[148:151], v[104:107], v[52:55], v[148:151]
    v_mfma_f32_16x16x32_bf16 v[152:155], v[108:111], v[36:39], v[152:155]
    v_mfma_f32_16x16x32_bf16 v[156:159], v[108:111], v[52:55], v[156:159]
    v_mfma_f32_16x16x32_bf16 v[160:163], v[112:115], v[36:39], v[160:163]
    v_mfma_f32_16x16x32_bf16 v[164:167], v[112:115], v[52:55], v[164:167]
    v_mfma_f32_16x16x32_bf16 v[168:171], v[116:119], v[36:39], v[168:171]
    v_mfma_f32_16x16x32_bf16 v[172:175], v[116:119], v[52:55], v[172:175]
    v_mfma_f32_16x16x32_bf16 v[176:179], v[120:123], v[36:39], v[176:179]
    v_mfma_f32_16x16x32_bf16 v[180:183], v[120:123], v[52:55], v[180:183]
    v_mfma_f32_16x16x32_bf16 v[184:187], v[124:127], v[36:39], v[184:187]
    v_mfma_f32_16x16x32_bf16 v[188:191], v[124:127], v[52:55], v[188:191]
    s_waitcnt lgkmcnt(0)
    ds_read_b128 v[96:99], v19 offset:0
    ds_read_b128 v[100:103], v19 offset:16384
    ds_read_b128 v[104:107], v19 offset:256
    ds_read_b128 v[108:111], v19 offset:16640
    ds_read_b128 v[112:115], v19 offset:512
    ds_read_b128 v[116:119], v19 offset:16896
    ds_read_b128 v[120:123], v19 offset:768
    ds_read_b128 v[124:127], v19 offset:17152
    v_mfma_f32_16x16x32_bf16 v[192:195], v[216:219], v[40:43], v[192:195]
    v_mfma_f32_16x16x32_bf16 v[196:199], v[216:219], v[56:59], v[196:199]
    v_mfma_f32_16x16x32_bf16 v[128:131], v[64:67], v[40:43], v[128:131]
    v_mfma_f32_16x16x32_bf16 v[132:135], v[64:67], v[56:59], v[132:135]
    v_mfma_f32_16x16x32_bf16 v[136:139], v[68:71], v[40:43], v[136:139]
    v_mfma_f32_16x16x32_bf16 v[140:143], v[68:71], v[56:59], v[140:143]
    v_mfma_f32_16x16x32_bf16 v[144:147], v[72:75], v[40:43], v[144:147]
    v_mfma_f32_16x16x32_bf16 v[148:151], v[72:75], v[56:59], v[148:151]
    v_mfma_f32_16x16x32_bf16 v[152:155], v[76:79], v[40:43], v[152:155]
    v_mfma_f32_16x16x32_bf16 v[156:159], v[76:79], v[56:59], v[156:159]
    v_mfma_f32_16x16x32_bf16 v[160:163], v[80:83], v[40:43], v[160:163]
    v_mfma_f32_16x16x32_bf16 v[164:167], v[80:83], v[56:59], v[164:167]
    v_mfma_f32_16x16x32_bf16 v[168:171], v[84:87], v[40:43], v[168:171]
    v_mfma_f32_16x16x32_bf16 v[172:175], v[84:87], v[56:59], v[172:175]
    v_mfma_f32_16x16x32_bf16 v[176:179], v[88:91], v[40:43], v[176:179]
    v_mfma_f32_16x16x32_bf16 v[180:183], v[88:91], v[56:59], v[180:183]
    v_mfma_f32_16x16x32_bf16 v[184:187], v[92:95], v[40:43], v[184:187]
    v_mfma_f32_16x16x32_bf16 v[188:191], v[92:95], v[56:59], v[188:191]
    s_waitcnt lgkmcnt(0)
    s_barrier
    ds_read_b128 v[88:91], v9
    ds_read_b128 v[92:95], v9 offset:64
    ds_read_b128 v[80:83], v9 offset:128
    ds_read_b128 v[84:87], v9 offset:192
    v_mfma_f32_16x16x32_bf16 v[192:195], v[216:219], v[44:47], v[192:195]
    v_mfma_f32_16x16x32_bf16 v[196:199], v[216:219], v[60:63], v[196:199]
    v_mfma_f32_16x16x32_bf16 v[128:131], v[96:99], v[44:47], v[128:131]
    v_mfma_f32_16x16x32_bf16 v[132:135], v[96:99], v[60:63], v[132:135]
    v_mfma_f32_16x16x32_bf16 v[136:139], v[100:103], v[44:47], v[136:139]
    v_mfma_f32_16x16x32_bf16 v[140:143], v[100:103], v[60:63], v[140:143]
    s_waitcnt lgkmcnt(0)
    v_pk_mul_f32 v[88:89], v[88:89], v[220:221]
    v_pk_mul_f32 v[90:91], v[90:91], v[220:221]
    v_mfma_f32_16x16x32_bf16 v[144:147], v[104:107], v[44:47], v[144:147]
    v_pk_mul_f32 v[92:93], v[92:93], v[220:221]
    v_pk_mul_f32 v[94:95], v[94:95], v[220:221]
    v_pk_fma_f32 v[80:81], v[80:81], v[220:221], v[222:223]
    v_mfma_f32_16x16x32_bf16 v[148:151], v[104:107], v[60:63], v[148:151]
    v_pk_fma_f32 v[82:83], v[82:83], v[220:221], v[222:223]
    v_pk_fma_f32 v[84:85], v[84:85], v[220:221], v[222:223]
    v_pk_fma_f32 v[86:87], v[86:87], v[220:221], v[222:223]
    v_mfma_f32_16x16x32_bf16 v[152:155], v[108:111], v[44:47], v[152:155]
    v_pk_fma_f32 v[80:81], v[88:89], v[88:89], v[80:81] neg_lo:[1,0,0] neg_hi:[1,0,0]
    v_pk_fma_f32 v[82:83], v[90:91], v[90:91], v[82:83] neg_lo:[1,0,0] neg_hi:[1,0,0]
    v_pk_fma_f32 v[84:85], v[92:93], v[92:93], v[84:85] neg_lo:[1,0,0] neg_hi:[1,0,0]
    v_mfma_f32_16x16x32_bf16 v[156:159], v[108:111], v[60:63], v[156:159]
    v_pk_fma_f32 v[86:87], v[94:95], v[94:95], v[86:87] neg_lo:[1,0,0] neg_hi:[1,0,0]
    v_max_f32 v80, v222, v80
    v_max_f32 v81, v222, v81
    v_mfma_f32_16x16x32_bf16 v[160:163], v[112:115], v[44:47], v[160:163]
    v_max_f32 v82, v222, v82
    v_max_f32 v83, v222, v83
    v_max_f32 v84, v222, v84
    v_mfma_f32_16x16x32_bf16 v[164:167], v[112:115], v[60:63], v[164:167]
    v_max_f32 v85, v222, v85
    v_max_f32 v86, v222, v86
    v_max_f32 v87, v222, v87
    v_mfma_f32_16x16x32_bf16 v[168:171], v[116:119], v[44:47], v[168:171]
    v_rsq_f32 v80, v80
    v_rsq_f32 v81, v81
    v_rsq_f32 v82, v82
    v_mfma_f32_16x16x32_bf16 v[172:175], v[116:119], v[60:63], v[172:175]
    v_rsq_f32 v83, v83
    v_rsq_f32 v84, v84
    v_rsq_f32 v85, v85
    v_mfma_f32_16x16x32_bf16 v[176:179], v[120:123], v[44:47], v[176:179]
    v_rsq_f32 v86, v86
    v_rsq_f32 v87, v87
    v_mov_b32 v73, v81
    v_mfma_f32_16x16x32_bf16 v[180:183], v[120:123], v[60:63], v[180:183]
    v_mov_b32 v75, v83
    v_cndmask_b32 v81, v81, 0, s[94:95]
    v_cndmask_b32 v83, v83, 0, s[94:95]
    v_mfma_f32_16x16x32_bf16 v[184:187], v[124:127], v[44:47], v[184:187]
    v_mfma_f32_16x16x32_bf16 v[188:191], v[124:127], v[60:63], v[188:191]
    v_mul_f32 v192, v206, v192
    v_mul_f32 v196, v206, v196
    s_nop 3
    v_pk_fma_f32 v[128:129], v[200:201], v[160:161], v[128:129]
    v_pk_fma_f32 v[132:133], v[200:201], v[164:165], v[132:133]
    v_pk_add_f32 v[208:209], v[144:145], v[176:177]
    v_pk_add_f32 v[210:211], v[148:149], v[180:181] neg_lo:[0,1] neg_hi:[0,1]
    v_pk_add_f32 v[212:213], v[148:149], v[180:181]
    v_pk_add_f32 v[214:215], v[176:177], v[144:145] neg_lo:[0,1] neg_hi:[0,1]
    v_pk_fma_f32 v[128:129], v[202:203], v[208:209], v[128:129]
    v_pk_fma_f32 v[132:133], v[202:203], v[212:213], v[132:133]
    v_pk_fma_f32 v[128:129], v[204:205], v[210:211], v[128:129]
    v_pk_fma_f32 v[132:133], v[204:205], v[214:215], v[132:133]
    v_pk_fma_f32 v[130:131], v[200:201], v[162:163], v[130:131]
    v_pk_fma_f32 v[134:135], v[200:201], v[166:167], v[134:135]
    v_pk_add_f32 v[208:209], v[146:147], v[178:179]
    v_pk_add_f32 v[210:211], v[150:151], v[182:183] neg_lo:[0,1] neg_hi:[0,1]
    v_pk_add_f32 v[212:213], v[150:151], v[182:183]
    v_pk_add_f32 v[214:215], v[178:179], v[146:147] neg_lo:[0,1] neg_hi:[0,1]
    v_pk_fma_f32 v[130:131], v[202:203], v[208:209], v[130:131]
    v_pk_fma_f32 v[134:135], v[202:203], v[212:213], v[134:135]
    v_pk_fma_f32 v[130:131], v[204:205], v[210:211], v[130:131]
    v_pk_fma_f32 v[134:135], v[204:205], v[214:215], v[134:135]
    v_pk_fma_f32 v[136:137], v[200:201], v[168:169], v[136:137]
    v_pk_fma_f32 v[140:141], v[200:201], v[172:173], v[140:141]
    v_pk_add_f32 v[208:209], v[152:153], v[184:185]
    v_pk_add_f32 v[210:211], v[156:157], v[188:189] neg_lo:[0,1] neg_hi:[0,1]
    v_pk_add_f32 v[212:213], v[156:157], v[188:189]
    v_pk_add_f32 v[214:215], v[184:185], v[152:153] neg_lo:[0,1] neg_hi:[0,1]
    v_pk_fma_f32 v[136:137], v[202:203], v[208:209], v[136:137]
    v_pk_fma_f32 v[140:141], v[202:203], v[212:213], v[140:141]
    v_pk_fma_f32 v[136:137], v[204:205], v[210:211], v[136:137]
    v_pk_fma_f32 v[140:141], v[204:205], v[214:215], v[140:141]
    v_pk_fma_f32 v[138:139], v[200:201], v[170:171], v[138:139]
    v_pk_fma_f32 v[142:143], v[200:201], v[174:175], v[142:143]
    v_pk_add_f32 v[208:209], v[154:155], v[186:187]
    v_pk_add_f32 v[210:211], v[158:159], v[190:191] neg_lo:[0,1] neg_hi:[0,1]
    v_pk_add_f32 v[212:213], v[158:159], v[190:191]
    v_pk_add_f32 v[214:215], v[186:187], v[154:155] neg_lo:[0,1] neg_hi:[0,1]
    v_pk_fma_f32 v[138:139], v[202:203], v[208:209], v[138:139]
    v_pk_fma_f32 v[142:143], v[202:203], v[212:213], v[142:143]
    v_pk_fma_f32 v[138:139], v[204:205], v[210:211], v[138:139]
    v_pk_fma_f32 v[142:143], v[204:205], v[214:215], v[142:143]
    v_fma_f32 v128, -v88, v192, v128
    v_fma_f32 v129, -v89, v192, v129
    v_fma_f32 v130, -v90, v192, v130
    v_fma_f32 v131, -v91, v192, v131
    v_mul_f32 v108, v80, v128
    v_mul_f32 v109, v82, v130
    v_fma_f32 v108, v81, v129, v108
    v_fma_f32 v109, v83, v131, v109
    v_add_f32 v100, v108, v109
    v_sub_f32 v102, v108, v109
    v_fma_f32 v132, -v88, v196, v132
    v_fma_f32 v133, -v89, v196, v133
    v_fma_f32 v134, -v90, v196, v134
    v_fma_f32 v135, -v91, v196, v135
    v_mul_f32 v108, v80, v132
    v_mul_f32 v109, v82, v134
    v_fma_f32 v108, -v81, v133, v108
    v_fma_f32 v109, -v83, v135, v109
    v_add_f32 v104, v108, v109
    v_sub_f32 v106, v108, v109
    v_fma_f32 v136, -v92, v192, v136
    v_fma_f32 v137, -v93, v192, v137
    v_fma_f32 v138, -v94, v192, v138
    v_fma_f32 v139, -v95, v192, v139
    v_mul_f32 v108, v84, v136
    v_mul_f32 v109, v86, v138
    v_fma_f32 v108, v85, v137, v108
    v_fma_f32 v109, v87, v139, v109
    v_add_f32 v101, v108, v109
    v_sub_f32 v103, v108, v109
    v_fma_f32 v140, -v92, v196, v140
    v_fma_f32 v141, -v93, v196, v141
    v_fma_f32 v142, -v94, v196, v142
    v_fma_f32 v143, -v95, v196, v143
    v_mul_f32 v108, v84, v140
    v_mul_f32 v109, v86, v142
    v_fma_f32 v108, -v85, v141, v108
    v_fma_f32 v109, -v87, v143, v109
    v_add_f32 v105, v108, v109
    v_sub_f32 v107, v108, v109
    v_cvt_pk_bf16_f32 v112, v100, v101
    v_cvt_pk_bf16_f32 v113, v102, v103
    v_cvt_pk_bf16_f32 v114, v104, v105
    v_cvt_pk_bf16_f32 v115, v106, v107
    s_nop 1
    v_permlane32_swap_b32 v112, v114
    v_permlane32_swap_b32 v113, v115
    s_nop 1
    v_permlane16_swap_b32 v112, v113
    v_permlane16_swap_b32 v114, v115
    s_nop 0
    buffer_store_dwordx4 v[112:115], v12, s[44:47], 0 offen sc1
    s_cmp_lg_u32 s6, 0
    s_cbranch_scc1 L_noex
    v_mul_f32 v108, v73, v129
    v_mul_f32 v109, v73, v133
    v_fma_f32 v108, v75, v131, v108
    v_fma_f32 v109, -v75, v135, v109
    s_lshl_b32 s76, s7, 8
    s_lshl_b32 s77, s3, 6
    s_add_u32 s76, s76, s77
    v_lshl_add_u32 v110, v2, 2, s76
    s_mov_b64 exec, 0xffff
    buffer_store_dword v108, v110, s[48:51], 0 offen sc1
    buffer_store_dword v109, v110, s[48:51], 0 offen offset:1024 sc1
    s_mov_b64 exec, -1
L_noex:
    s_cmp_lg_u32 s3, 0
    s_cbranch_scc1 L_rdy_done
    v_mov_b32 v4, 0
    s_mov_b64 exec, 1
    s_mov_b32 s76, 0
L_rdy_loop:
    buffer_load_dword v5, v4, s[68:71], 0 offen sc1
    s_add_u32 s76, s76, 1
    s_cmp_ge_u32 s76, 0x40000
    s_cbranch_scc1 L_rdy_exit
    s_waitcnt vmcnt(0)
    v_cmp_eq_u32 vcc, 0, v5
    s_cbranch_vccnz L_rdy_loop
L_rdy_exit:
    s_mov_b64 exec, -1
L_rdy_done:
    v_lshrrev_b32 v4, 2, v2
    v_and_b32 v5, 3, v2
    v_xor_b32 v5, v5, v1
    v_lshlrev_b32 v5, 4, v5
    v_lshl_add_u32 v5, v2, 10, v5
    s_mul_i32 s76, s85, 49152
    s_add_u32 s76, s76, 98048
    s_lshl_b32 s77, s85, 15
    s_sub_u32 s77, 16384, s77
    v_add_u32 v5, s76, v5
    v_xor_b32 v6, 0, v4
    v_lshl_add_u32 v8, v6, 6, v5
    v_add_u32 v16, s77, v8
    v_xor_b32 v6, 1, v4
    v_lshl_add_u32 v9, v6, 6, v5
    v_add_u32 v17, s77, v9
    v_xor_b32 v6, 2, v4
    v_lshl_add_u32 v10, v6, 6, v5
    v_add_u32 v18, s77, v10
    v_xor_b32 v6, 3, v4
    v_lshl_add_u32 v11, v6, 6, v5
    v_add_u32 v19, s77, v11
    s_lshl_b32 s76, s85, 12
    s_add_u32 s76, s76, 81664
    v_lshl_add_u32 v4, v2, 8, s76
    s_lshl_b32 s77, s86, 5
    v_lshl_add_u32 v5, v1, 3, s77
    v_lshlrev_b32 v7, 4, v2
    v_xor_b32 v6, v5, v7
    v_add_u32 v20, v4, v6
    v_sub_u32 v6, 120, v5
    v_xor_b32 v6, v6, v7
    v_add_u32 v21, v4, v6
    v_sub_u32 v6, 128, v5
    v_cmp_eq_u32 s[94:95], 0, v28
    v_mov_b32 v23, 144
    s_nop 0
    v_cndmask_b32 v6, v6, v23, s[94:95]
    v_xor_b32 v6, v6, v7
    v_add_u32 v22, v4, v6
    s_waitcnt vmcnt(0)
    s_mov_b64 exec, 1
    ds_add_rtn_u32 v4, v14, v15 offset:20
    s_mov_b64 exec, -1
    s_waitcnt lgkmcnt(0)
    v_readfirstlane_b32 s76, v4
    s_nop 3
    s_cmp_lg_u32 s76, 3
    s_cbranch_scc1 L_ar1_skip
    s_mov_b64 exec, 0xf
    buffer_atomic_add v15, v29, s[52:55], 0 offen sc1
    s_mov_b64 exec, -1
L_ar1_skip:
    s_lshl_b32 s76, s3, 2
    v_add_u32 v29, s76, v14
    s_mov_b32 s79, 0
L_wtrig_l:
    ds_read_b32 v4, v14 offset:0
    s_add_u32 s79, s79, 1
    s_waitcnt lgkmcnt(0)
    v_readfirstlane_b32 s78, v4
    s_cmp_ge_u32 s79, 0x200000
    s_cbranch_scc1 L_wtrig_x
    s_cmp_lt_u32 s78, 4
    s_cbranch_scc1 L_wtrig_l
L_wtrig_x:
    ds_read_b64 v[36:37], v20 offset:0
    ds_read_b64 v[38:39], v21 offset:0
    ds_read_u16 v40, v22 offset:0
    ds_read_b64 v[42:43], v20 offset:8192
    ds_read_b64 v[44:45], v21 offset:8192
    ds_read_u16 v46, v22 offset:8192
    ds_read_b128 v[128:131], v8 offset:0
    ds_read_b128 v[192:195], v16 offset:0
    ds_read_b128 v[132:135], v9 offset:0
    ds_read_b128 v[196:199], v17 offset:0
    ds_read_b128 v[136:139], v10 offset:0
    ds_read_b128 v[200:203], v18 offset:0
    ds_read_b128 v[140:143], v11 offset:0
    ds_read_b128 v[204:207], v19 offset:0
    ds_read_b128 v[144:147], v8 offset:256
    ds_read_b128 v[208:211], v16 offset:256
    ds_read_b128 v[148:151], v9 offset:256
    ds_read_b128 v[212:215], v17 offset:256
    ds_read_b128 v[152:155], v10 offset:256
    ds_read_b128 v[216:219], v18 offset:256
    ds_read_b128 v[156:159], v11 offset:256
    ds_read_b128 v[220:223], v19 offset:256
    ds_read_b128 v[160:163], v8 offset:512
    ds_read_b128 v[224:227], v16 offset:512
    ds_read_b128 v[164:167], v9 offset:512
    ds_read_b128 v[228:231], v17 offset:512
    ds_read_b128 v[168:171], v10 offset:512
    ds_read_b128 v[232:235], v18 offset:512
    ds_read_b128 v[172:175], v11 offset:512
    ds_read_b128 v[236:239], v19 offset:512
    ds_read_b128 v[176:179], v8 offset:768
    ds_read_b128 v[240:243], v16 offset:768
    ds_read_b128 v[180:183], v9 offset:768
    ds_read_b128 v[244:247], v17 offset:768
    ds_read_b128 v[184:187], v10 offset:768
    ds_read_b128 v[248:251], v18 offset:768
    ds_read_b128 v[188:191], v11 offset:768
    ds_read_b128 v[252:255], v19 offset:768
    s_waitcnt lgkmcnt(15)
    v_lshlrev_b32 v48, 16, v36
    v_and_b32 v49, s84, v36
    v_lshlrev_b32 v50, 16, v37
    v_and_b32 v51, s84, v37
    v_lshlrev_b32 v52, 16, v40
    v_and_b32 v53, s84, v39
    v_lshlrev_b32 v54, 16, v39
    v_and_b32 v55, s84, v38
    v_lshlrev_b32 v56, 16, v42
    v_and_b32 v57, s84, v42
    v_lshlrev_b32 v58, 16, v43
    v_and_b32 v59, s84, v43
    v_lshlrev_b32 v60, 16, v46
    v_and_b32 v61, s84, v45
    v_lshlrev_b32 v62, 16, v45
    v_and_b32 v63, s84, v44
    v_lshlrev_b32 v24, 16, v24
    v_lshlrev_b32 v25, 16, v25
    s_lshl_b32 s76, s85, 1
    s_add_u32 s76, s76, s10
    s_lshl_b32 s76, s76, 18
    s_lshl_b32 s77, s9, 1
    s_add_u32 s77, s77, s86
    s_lshl_b32 s78, s77, 14
    s_add_u32 s76, s76, s78
    v_add_u32 v8, s76, v3
    v_lshlrev_b32 v9, 1, v28
    s_lshl_b32 s76, s10, 10
    v_add_u32 v9, s76, v9
    v_mov_b32 v32, 0xbf803f80
    v_mov_b32 v33, 0xbf803f80
    v_mov_b32 v34, 0xbf803f80
    v_mov_b32 v35, 0xbf803f80
    s_lshl_b32 s76, s8, 16
    s_lshl_b32 s78, s85, 14
    s_add_u32 s76, s76, s78
    s_lshl_b32 s78, s77, 10
    s_add_u32 s76, s76, s78
    v_add_u32 v10, s76, v3
    s_lshl_b32 s76, s8, 13
    s_lshl_b32 s78, s85, 11
    s_add_u32 s76, s76, s78
    s_lshl_b32 s77, s77, 7
    s_add_u32 s76, s76, s77
    v_lshrrev_b32 v11, 1, v1
    v_and_b32 v12, 1, v1
    v_lshlrev_b32 v11, 12, v11
    v_lshl_add_u32 v11, v12, 2, v11
    v_lshl_add_u32 v11, v2, 3, v11
    v_add_u32 v11, s76, v11
    s_lshl_b32 s76, s3, 10
    s_add_u32 s76, s76, 147456
    v_add_u32 v12, s76, v3
    s_xor_b32 s76, s76, 0x800
    v_add_u32 v13, s76, v3
    s_cmp_eq_u32 s10, 0
    s_cselect_b32 s87, 1.0, -1.0
    s_cmp_eq_u32 s85, 0
    s_cselect_b32 s88, 1.0, -1.0
    s_mov_b32 s90, 0x8000
    s_waitcnt lgkmcnt(0)
    s_mov_b64 exec, 1
    ds_add_u32 v14, v15 offset:4
    s_mov_b64 exec, -1
    v_xor_b32 v16, 8, v29
    s_cmp_lg_u32 s3, 0
    s_cbranch_scc1 L_p1_others
    s_mov_b64 exec, 0xf
    s_mov_b32 s76, 0
L_p1_loop:
    buffer_load_dword v4, v30, s[52:55], 0 offen sc1
    s_add_u32 s76, s76, 1
    s_cmp_ge_u32 s76, 0x40000
    s_cbranch_scc1 L_p1_exit
    s_waitcnt vmcnt(0)
    v_cmp_gt_u32 vcc, 16, v4
    s_cbranch_vccnz L_p1_loop
L_p1_exit:
    s_mov_b64 exec, -1
    s_mov_b64 exec, 1
    ds_add_u32 v14, v15 offset:32
    s_mov_b64 exec, -1
    s_branch L_p1_done
L_p1_others:
    s_mov_b32 s79, 0
L_p1_w_l:
    ds_read_b32 v4, v14 offset:32
    s_add_u32 s79, s79, 1
    s_waitcnt lgkmcnt(0)
    v_readfirstlane_b32 s78, v4
    s_cmp_ge_u32 s79, 0x200000
    s_cbranch_scc1 L_p1_w_x
    s_cmp_lt_u32 s78, 1
    s_cbranch_scc1 L_p1_w_l
L_p1_w_x:
L_p1_done:
    buffer_load_dwordx4 v[64:67], v8, s[44:47], 0 offen offset:0 sc1
    buffer_load_dwordx4 v[68:71], v8, s[44:47], 0 offen offset:1024 sc1
    buffer_load_dwordx4 v[72:75], v8, s[44:47], 0 offen offset:2048 sc1
    buffer_load_dwordx4 v[76:79], v8, s[44:47], 0 offen offset:3072 sc1
    buffer_load_dwordx4 v[80:83], v8, s[44:47], s80 offen offset:0 sc1
    buffer_load_dwordx4 v[84:87], v8, s[44:47], s80 offen offset:1024 sc1
    buffer_load_dwordx4 v[88:91], v8, s[44:47], s80 offen offset:2048 sc1
    buffer_load_dwordx4 v[92:95], v8, s[44:47], s80 offen offset:3072 sc1
    buffer_load_dwordx4 v[96:99], v8, s[44:47], s81 offen offset:0 sc1
    buffer_load_dwordx4 v[100:103], v8, s[44:47], s81 offen offset:1024 sc1
    buffer_load_dwordx4 v[104:107], v8, s[44:47], s81 offen offset:2048 sc1
    buffer_load_dwordx4 v[108:111], v8, s[44:47], s81 offen offset:3072 sc1
    buffer_load_dwordx4 v[112:115], v8, s[44:47], s82 offen offset:0 sc1
    buffer_load_dwordx4 v[116:119], v8, s[44:47], s82 offen offset:1024 sc1
    buffer_load_dwordx4 v[120:123], v8, s[44:47], s82 offen offset:2048 sc1
    buffer_load_dwordx4 v[124:127], v8, s[44:47], s82 offen offset:3072 sc1
    buffer_load_dwordx4 v[20:23], v9, s[48:51], 0 offen sc1
    s_waitcnt vmcnt(16)
    v_mfma_f32_16x16x32_bf16 v[40:43], v[64:67], v[192:195], 0
    v_mfma_f32_16x16x32_bf16 v[36:39], v[64:67], v[128:131], 0
    v_mfma_f32_16x16x32_bf16 v[44:47], v[64:67], v[32:35], 0
    s_waitcnt vmcnt(15)
    v_mfma_f32_16x16x32_bf16 v[40:43], v[68:71], v[196:199], v[40:43]
    v_mfma_f32_16x16x32_bf16 v[36:39], v[68:71], v[132:135], v[36:39]
    v_mfma_f32_16x16x32_bf16 v[44:47], v[68:71], v[32:35], v[44:47]
    s_waitcnt vmcnt(14)
    v_mfma_f32_16x16x32_bf16 v[40:43], v[72:75], v[200:203], v[40:43]
    v_mfma_f32_16x16x32_bf16 v[36:39], v[72:75], v[136:139], v[36:39]
    v_mfma_f32_16x16x32_bf16 v[44:47], v[72:75], v[32:35], v[44:47]
    s_waitcnt vmcnt(13)
    v_mfma_f32_16x16x32_bf16 v[40:43], v[76:79], v[204:207], v[40:43]
    v_mfma_f32_16x16x32_bf16 v[36:39], v[76:79], v[140:143], v[36:39]
    v_mfma_f32_16x16x32_bf16 v[44:47], v[76:79], v[32:35], v[44:47]
    s_waitcnt vmcnt(12)
    v_mfma_f32_16x16x32_bf16 v[40:43], v[80:83], v[208:211], v[40:43]
    v_mfma_f32_16x16x32_bf16 v[36:39], v[80:83], v[144:147], v[36:39]
    v_mfma_f32_16x16x32_bf16 v[44:47], v[80:83], v[32:35], v[44:47]
    s_waitcnt vmcnt(0)
    v_mfma_f32_16x16x32_bf16 v[40:43], v[84:87], v[212:215], v[40:43]
    v_mfma_f32_16x16x32_bf16 v[36:39], v[84:87], v[148:151], v[36:39]
    v_mfma_f32_16x16x32_bf16 v[44:47], v[84:87], v[32:35], v[44:47]
    v_mfma_f32_16x16x32_bf16 v[40:43], v[88:91], v[216:219], v[40:43]
    v_mfma_f32_16x16x32_bf16 v[36:39], v[88:91], v[152:155], v[36:39]
    v_mfma_f32_16x16x32_bf16 v[44:47], v[88:91], v[32:35], v[44:47]
    v_mfma_f32_16x16x32_bf16 v[40:43], v[92:95], v[220:223], v[40:43]
    v_mfma_f32_16x16x32_bf16 v[36:39], v[92:95], v[156:159], v[36:39]
    v_mfma_f32_16x16x32_bf16 v[44:47], v[92:95], v[32:35], v[44:47]
    v_mfma_f32_16x16x32_bf16 v[40:43], v[96:99], v[224:227], v[40:43]
    v_mfma_f32_16x16x32_bf16 v[36:39], v[96:99], v[160:163], v[36:39]
    v_mfma_f32_16x16x32_bf16 v[44:47], v[96:99], v[32:35], v[44:47]
    v_mfma_f32_16x16x32_bf16 v[40:43], v[100:103], v[228:231], v[40:43]
    v_mfma_f32_16x16x32_bf16 v[36:39], v[100:103], v[164:167], v[36:39]
    v_mfma_f32_16x16x32_bf16 v[44:47], v[100:103], v[32:35], v[44:47]
    v_mfma_f32_16x16x32_bf16 v[40:43], v[104:107], v[232:235], v[40:43]
    v_mfma_f32_16x16x32_bf16 v[36:39], v[104:107], v[168:171], v[36:39]
    v_mfma_f32_16x16x32_bf16 v[44:47], v[104:107], v[32:35], v[44:47]
    v_mfma_f32_16x16x32_bf16 v[40:43], v[108:111], v[236:239], v[40:43]
    v_mfma_f32_16x16x32_bf16 v[36:39], v[108:111], v[172:175], v[36:39]
    v_mfma_f32_16x16x32_bf16 v[44:47], v[108:111], v[32:35], v[44:47]
    v_mfma_f32_16x16x32_bf16 v[40:43], v[112:115], v[240:243], v[40:43]
    v_mfma_f32_16x16x32_bf16 v[36:39], v[112:115], v[176:179], v[36:39]
    v_mfma_f32_16x16x32_bf16 v[44:47], v[112:115], v[32:35], v[44:47]
    v_mfma_f32_16x16x32_bf16 v[40:43], v[116:119], v[244:247], v[40:43]
    v_mfma_f32_16x16x32_bf16 v[36:39], v[116:119], v[180:183], v[36:39]
    v_mfma_f32_16x16x32_bf16 v[44:47], v[116:119], v[32:35], v[44:47]
    v_mfma_f32_16x16x32_bf16 v[40:43], v[120:123], v[248:251], v[40:43]
    v_mfma_f32_16x16x32_bf16 v[36:39], v[120:123], v[184:187], v[36:39]
    v_mfma_f32_16x16x32_bf16 v[44:47], v[120:123], v[32:35], v[44:47]
    v_mfma_f32_16x16x32_bf16 v[40:43], v[124:127], v[252:255], v[40:43]
    v_mfma_f32_16x16x32_bf16 v[36:39], v[124:127], v[188:191], v[36:39]
    v_mfma_f32_16x16x32_bf16 v[44:47], v[124:127], v[32:35], v[44:47]
    s_mov_b32 s79, 0
L_wtc_l:
    ds_read_b32 v4, v14 offset:4
    s_add_u32 s79, s79, 1
    s_waitcnt lgkmcnt(0)
    v_readfirstlane_b32 s78, v4
    s_cmp_ge_u32 s79, 0x200000
    s_cbranch_scc1 L_wtc_x
    s_cmp_lt_u32 s78, 4
    s_cbranch_scc1 L_wtc_l
L_wtc_x:
    ds_write_b128 v12, v[40:43]
    s_waitcnt lgkmcnt(0)
    s_mov_b64 exec, 1
    ds_add_u32 v29, v15 offset:48
    s_mov_b64 exec, -1
    v_mul_f32 v64, v24, v20
    v_mul_f32 v68, v25, v20
    v_mul_f32 v65, v24, v21
    v_mul_f32 v69, v25, v21
    v_mul_f32 v66, v24, v22
    v_mul_f32 v70, v25, v22
    v_mul_f32 v67, v24, v23
    v_mul_f32 v71, v25, v23
    v_cmp_eq_u32 vcc, 0, v26
    s_mov_b32 s79, 0
L_wx_l:
    ds_read_b32 v4, v16 offset:48
    s_add_u32 s79, s79, 1
    s_waitcnt lgkmcnt(0)
    v_readfirstlane_b32 s78, v4
    s_cmp_ge_u32 s79, 0x200000
    s_cbranch_scc1 L_wx_x
    s_cmp_lt_u32 s78, 1
    s_cbranch_scc1 L_wx_l
L_wx_x:
    ds_read_b128 v[72:75], v13
    s_waitcnt lgkmcnt(0)
    v_sub_f32 v76, v36, v72
    v_add_f32 v80, v36, v72
    v_sub_f32 v77, v37, v73
    v_add_f32 v81, v37, v73
    v_sub_f32 v78, v38, v74
    v_add_f32 v82, v38, v74
    v_sub_f32 v79, v39, v75
    v_add_f32 v83, v39, v75
    v_mul_f32 v76, s88, v76
    v_cndmask_b32 v84, v80, v44, vcc
    v_mul_f32 v77, s88, v77
    v_cndmask_b32 v85, v81, v45, vcc
    v_mul_f32 v78, s88, v78
    v_cndmask_b32 v86, v82, v46, vcc
    v_mul_f32 v79, s88, v79
    v_cndmask_b32 v87, v83, v47, vcc
    v_cndmask_b32 v88, v76, v44, vcc
    v_cndmask_b32 v89, v77, v45, vcc
    v_cndmask_b32 v90, v78, v46, vcc
    v_cndmask_b32 v91, v79, v47, vcc
    v_fmac_f32 v76, s87, v64
    v_add_f32 v80, v80, v64
    v_add_f32 v84, v84, v68
    v_fmac_f32 v88, s87, v68
    v_fmac_f32 v77, s87, v65
    v_add_f32 v81, v81, v65
    v_add_f32 v85, v85, v69
    v_fmac_f32 v89, s87, v69
    v_fmac_f32 v78, s87, v66
    v_add_f32 v82, v82, v66
    v_add_f32 v86, v86, v70
    v_fmac_f32 v90, s87, v70
    v_fmac_f32 v79, s87, v67
    v_add_f32 v83, v83, v67
    v_add_f32 v87, v87, v71
    v_fmac_f32 v91, s87, v71
    v_cndmask_b32 v76, v76, 0, s[94:95]
    v_cndmask_b32 v84, v84, 0, s[94:95]
    v_pk_add_f32 v[76:77], v[76:77], v[48:49]
    v_pk_add_f32 v[78:79], v[78:79], v[50:51]
    v_pk_add_f32 v[80:81], v[80:81], v[52:53]
    v_pk_add_f32 v[82:83], v[82:83], v[54:55]
    v_pk_add_f32 v[84:85], v[84:85], v[56:57]
    v_pk_add_f32 v[86:87], v[86:87], v[58:59]
    v_pk_add_f32 v[88:89], v[88:89], v[60:61]
    v_pk_add_f32 v[90:91], v[90:91], v[62:63]
    v_cvt_pk_bf16_f32 v92, v76, v77
    v_cvt_pk_bf16_f32 v93, v78, v79
    v_cvt_pk_bf16_f32 v94, v80, v81
    v_cvt_pk_bf16_f32 v95, v82, v83
    v_cvt_pk_bf16_f32 v96, v84, v85
    v_cvt_pk_bf16_f32 v97, v86, v87
    v_cvt_pk_bf16_f32 v98, v88, v89
    v_cvt_pk_bf16_f32 v99, v90, v91
    v_mov_b32 v100, 0
    v_mov_b32 v101, 0
    v_mov_b32 v102, 0
    v_mov_b32 v103, 0
    buffer_store_dwordx4 v[92:95], v10, s[60:63], 0 offen sc1
    buffer_store_dwordx4 v[96:99], v10, s[60:63], s90 offen sc1
    v_dot2c_f32_bf16 v100, s83, v92
    v_dot2c_f32_bf16 v101, v92, v92
    v_dot2c_f32_bf16 v100, s83, v93
    v_dot2c_f32_bf16 v101, v93, v93
    v_dot2c_f32_bf16 v100, s83, v94
    v_dot2c_f32_bf16 v101, v94, v94
    v_dot2c_f32_bf16 v100, s83, v95
    v_dot2c_f32_bf16 v101, v95, v95
    v_dot2c_f32_bf16 v102, s83, v96
    v_dot2c_f32_bf16 v103, v96, v96
    v_dot2c_f32_bf16 v102, s83, v97
    v_dot2c_f32_bf16 v103, v97, v97
    v_dot2c_f32_bf16 v102, s83, v98
    v_dot2c_f32_bf16 v103, v98, v98
    v_dot2c_f32_bf16 v102, s83, v99
    v_dot2c_f32_bf16 v103, v99, v99
    s_nop 2
    v_permlane32_swap_b32 v100, v102
    v_permlane32_swap_b32 v101, v103
    s_nop 0
    v_add_f32 v100, v100, v102
    v_add_f32 v101, v101, v103
    s_nop 1
    v_permlane16_swap_b32 v100, v101
    s_nop 0
    v_add_f32 v100, v100, v101
    buffer_store_dword v100, v11, s[56:59], 0 offen sc1
    s_and_b32 s85, s5, 1
    v_add_u32 v24, 57344, v3
    s_lshl_b32 s76, s4, 17
    s_lshl_b32 s77, s3, 15
    s_add_u32 s76, s76, s77
    v_add_u32 v10, s76, v3
    v_add_u32 v11, 0x4000, v10
    s_lshl_b32 s76, s4, 14
    s_lshl_b32 s77, s3, 12
    s_add_u32 s76, s76, s77
    v_lshl_add_u32 v12, v2, 3, s76
    v_lshl_add_u32 v12, v1, 9, v12
    v_lshlrev_b32 v13, 4, v1
    v_add_u32 v13, 151552, v13
    s_waitcnt vmcnt(0)
    s_mov_b64 exec, 1
    ds_add_rtn_u32 v4, v14, v15 offset:24
    s_mov_b64 exec, -1
    s_waitcnt lgkmcnt(0)
    v_readfirstlane_b32 s76, v4
    s_nop 3
    s_cmp_lg_u32 s76, 3
    s_cbranch_scc1 L_ar2_skip
    s_mov_b64 exec, 1
    buffer_atomic_add v15, v31, s[52:55], 0 offen sc1
    s_mov_b64 exec, -1
L_ar2_skip:
    s_mov_b32 s79, 0
L_ww1_l:
    ds_read_b32 v4, v14 offset:8
    s_add_u32 s79, s79, 1
    s_waitcnt lgkmcnt(0)
    v_readfirstlane_b32 s78, v4
    s_cmp_ge_u32 s79, 0x200000
    s_cbranch_scc1 L_ww1_x
    s_cmp_lt_u32 s78, 4
    s_cbranch_scc1 L_ww1_l
L_ww1_x:
    s_cmp_lg_u32 s3, 0
    s_cbranch_scc1 L_p2_others
    s_mov_b64 exec, 1
    s_mov_b32 s76, 0
L_p2_loop:
    buffer_load_dword v4, v31, s[52:55], 0 offen sc1
    s_add_u32 s76, s76, 1
    s_cmp_ge_u32 s76, 0x40000
    s_cbranch_scc1 L_p2_exit
    s_waitcnt vmcnt(0)
    v_cmp_gt_u32 vcc, 16, v4
    s_cbranch_vccnz L_p2_loop
L_p2_exit:
    s_mov_b64 exec, -1
    s_mov_b64 exec, 1
    ds_add_u32 v14, v15 offset:36
    s_mov_b64 exec, -1
    s_branch L_p2_done
L_p2_others:
    s_mov_b32 s79, 0
L_p2_w_l:
    ds_read_b32 v4, v14 offset:36
    s_add_u32 s79, s79, 1
    s_waitcnt lgkmcnt(0)
    v_readfirstlane_b32 s78, v4
    s_cmp_ge_u32 s79, 0x200000
    s_cbranch_scc1 L_p2_w_x
    s_cmp_lt_u32 s78, 1
    s_cbranch_scc1 L_p2_w_l
L_p2_w_x:
L_p2_done:
    s_add_u32 s100, s98, 0
    s_and_b32 s100, s100, 15
    s_lshl_b32 s100, s100, 10
    buffer_load_dwordx4 v[124:127], v10, s[60:63], s100 offen sc1
    buffer_load_dwordx4 v[128:131], v11, s[60:63], s100 offen sc1
    s_add_u32 s100, s98, 1
    s_and_b32 s100, s100, 15
    s_lshl_b32 s100, s100, 10
    buffer_load_dwordx4 v[132:135], v10, s[60:63], s100 offen sc1
    buffer_load_dwordx4 v[136:139], v11, s[60:63], s100 offen sc1
    s_add_u32 s100, s98, 2
    s_and_b32 s100, s100, 15
    s_lshl_b32 s100, s100, 10
    buffer_load_dwordx4 v[140:143], v10, s[60:63], s100 offen sc1
    buffer_load_dwordx4 v[144:147], v11, s[60:63], s100 offen sc1
    s_add_u32 s100, s98, 3
    s_and_b32 s100, s100, 15
    s_lshl_b32 s100, s100, 10
    buffer_load_dwordx4 v[148:151], v10, s[60:63], s100 offen sc1
    buffer_load_dwordx4 v[152:155], v11, s[60:63], s100 offen sc1
    ds_read_b128 v[92:95], v3 offset:0
    ds_read_b128 v[96:99], v3 offset:1024
    ds_read_b128 v[100:103], v3 offset:2048
    ds_read_b128 v[104:107], v3 offset:3072
    s_lshl_b32 s76, s4, 3
    s_lshl_b32 s77, s3, 1
    s_add_u32 s76, s76, s77
    s_mul_i32 s76, s76, 57344
    s_mul_i32 s77, s5, 7
    s_add_u32 s78, s77, s85
    s_lshl_b32 s78, s78, 9
    s_add_u32 s78, s78, s76
    v_add_u32 v8, s78, v3
    s_cmp_eq_u32 s85, 0
    s_cselect_b32 s78, 6, 0
    s_add_u32 s77, s77, s78
    s_lshr_b32 s78, s77, 1
    s_lshl_b32 s78, s78, 10
    s_and_b32 s77, s77, 1
    s_lshl_b32 s77, s77, 3
    s_add_u32 s78, s78, s77
    s_add_u32 s78, s78, s76
    v_add_u32 v9, s78, v3
    s_mov_b32 s90, 57344
    s_mul_i32 s89, s3, 36864
    v_add_u32 v31, 4096, v31
    s_waitcnt vmcnt(6)
    ds_read_b128 v[108:111], v3 offset:7168
    s_waitcnt lgkmcnt(4)
    v_mfma_f32_16x16x32_bf16 v[36:39], v[92:95], v[124:127], 0
    v_mfma_f32_16x16x32_bf16 v[40:43], v[92:95], v[128:131], 0
    s_add_u32 s100, s98, 4
    s_and_b32 s100, s100, 15
    s_lshl_b32 s100, s100, 10
    buffer_load_dwordx4 v[156:159], v10, s[60:63], s100 offen sc1
    ds_read_b128 v[112:115], v3 offset:8192
    s_waitcnt lgkmcnt(4)
    v_mfma_f32_16x16x32_bf16 v[44:47], v[96:99], v[124:127], 0
    v_mfma_f32_16x16x32_bf16 v[48:51], v[96:99], v[128:131], 0
    ds_read_b128 v[116:119], v3 offset:9216
    s_waitcnt lgkmcnt(4)
    v_mfma_f32_16x16x32_bf16 v[52:55], v[100:103], v[124:127], 0
    v_mfma_f32_16x16x32_bf16 v[56:59], v[100:103], v[128:131], 0
    buffer_load_dwordx4 v[160:163], v11, s[60:63], s100 offen sc1
    ds_read_b128 v[120:123], v3 offset:10240
    s_waitcnt lgkmcnt(4)
    v_mfma_f32_16x16x32_bf16 v[60:63], v[104:107], v[124:127], 0
    v_mfma_f32_16x16x32_bf16 v[64:67], v[104:107], v[128:131], 0
    s_waitcnt vmcnt(6)
    ds_read_b128 v[92:95], v3 offset:14336
    s_waitcnt lgkmcnt(4)
    v_mfma_f32_16x16x32_bf16 v[36:39], v[108:111], v[132:135], v[36:39]
    v_mfma_f32_16x16x32_bf16 v[40:43], v[108:111], v[136:139], v[40:43]
    s_add_u32 s100, s98, 5
    s_and_b32 s100, s100, 15
    s_lshl_b32 s100, s100, 10
    buffer_load_dwordx4 v[164:167], v10, s[60:63], s100 offen sc1
    ds_read_b128 v[96:99], v3 offset:15360
    s_waitcnt lgkmcnt(4)
    v_mfma_f32_16x16x32_bf16 v[44:47], v[112:115], v[132:135], v[44:47]
    v_mfma_f32_16x16x32_bf16 v[48:51], v[112:115], v[136:139], v[48:51]
    ds_read_b128 v[100:103], v3 offset:16384
    s_waitcnt lgkmcnt(4)
    v_mfma_f32_16x16x32_bf16 v[52:55], v[116:119], v[132:135], v[52:55]
    v_mfma_f32_16x16x32_bf16 v[56:59], v[116:119], v[136:139], v[56:59]
    buffer_load_dwordx4 v[168:171], v11, s[60:63], s100 offen sc1
    ds_read_b128 v[104:107], v3 offset:17408
    s_waitcnt lgkmcnt(4)
    v_mfma_f32_16x16x32_bf16 v[60:63], v[120:123], v[132:135], v[60:63]
    v_mfma_f32_16x16x32_bf16 v[64:67], v[120:123], v[136:139], v[64:67]
    s_waitcnt vmcnt(6)
    ds_read_b128 v[108:111], v3 offset:21504
    s_waitcnt lgkmcnt(4)
    v_mfma_f32_16x16x32_bf16 v[36:39], v[92:95], v[140:143], v[36:39]
    v_mfma_f32_16x16x32_bf16 v[40:43], v[92:95], v[144:147], v[40:43]
    s_add_u32 s100, s98, 6
    s_and_b32 s100, s100, 15
    s_lshl_b32 s100, s100, 10
    buffer_load_dwordx4 v[172:175], v10, s[60:63], s100 offen sc1
    ds_read_b128 v[112:115], v3 offset:22528
    s_waitcnt lgkmcnt(4)
    v_mfma_f32_16x16x32_bf16 v[44:47], v[96:99], v[140:143], v[44:47]
    v_mfma_f32_16x16x32_bf16 v[48:51], v[96:99], v[144:147], v[48:51]
    ds_read_b128 v[116:119], v3 offset:23552
    s_waitcnt lgkmcnt(4)
    v_mfma_f32_16x16x32_bf16 v[52:55], v[100:103], v[140:143], v[52:55]
    v_mfma_f32_16x16x32_bf16 v[56:59], v[100:103], v[144:147], v[56:59]
    buffer_load_dwordx4 v[176:179], v11, s[60:63], s100 offen sc1
    ds_read_b128 v[120:123], v3 offset:24576
    s_waitcnt lgkmcnt(4)
    v_mfma_f32_16x16x32_bf16 v[60:63], v[104:107], v[140:143], v[60:63]
    v_mfma_f32_16x16x32_bf16 v[64:67], v[104:107], v[144:147], v[64:67]
    s_waitcnt vmcnt(6)
    ds_read_b128 v[92:95], v3 offset:28672
    s_waitcnt lgkmcnt(4)
    v_mfma_f32_16x16x32_bf16 v[36:39], v[108:111], v[148:151], v[36:39]
    v_mfma_f32_16x16x32_bf16 v[40:43], v[108:111], v[152:155], v[40:43]
    s_add_u32 s100, s98, 7
    s_and_b32 s100, s100, 15
    s_lshl_b32 s100, s100, 10
    buffer_load_dwordx4 v[180:183], v10, s[60:63], s100 offen sc1
    ds_read_b128 v[96:99], v3 offset:29696
    s_waitcnt lgkmcnt(4)
    v_mfma_f32_16x16x32_bf16 v[44:47], v[112:115], v[148:151], v[44:47]
    v_mfma_f32_16x16x32_bf16 v[48:51], v[112:115], v[152:155], v[48:51]
    ds_read_b128 v[100:103], v3 offset:30720
    s_waitcnt lgkmcnt(4)
    v_mfma_f32_16x16x32_bf16 v[52:55], v[116:119], v[148:151], v[52:55]
    v_mfma_f32_16x16x32_bf16 v[56:59], v[116:119], v[152:155], v[56:59]
    buffer_load_dwordx4 v[184:187], v11, s[60:63], s100 offen sc1
    ds_read_b128 v[104:107], v3 offset:31744
    s_waitcnt lgkmcnt(4)
    v_mfma_f32_16x16x32_bf16 v[60:63], v[120:123], v[148:151], v[60:63]
    v_mfma_f32_16x16x32_bf16 v[64:67], v[120:123], v[152:155], v[64:67]
    s_waitcnt vmcnt(6)
    ds_read_b128 v[108:111], v3 offset:35840
    s_waitcnt lgkmcnt(4)
    v_mfma_f32_16x16x32_bf16 v[36:39], v[92:95], v[156:159], v[36:39]
    v_mfma_f32_16x16x32_bf16 v[40:43], v[92:95], v[160:163], v[40:43]
    s_add_u32 s100, s98, 8
    s_and_b32 s100, s100, 15
    s_lshl_b32 s100, s100, 10
    buffer_load_dwordx4 v[188:191], v10, s[60:63], s100 offen sc1
    ds_read_b128 v[112:115], v3 offset:36864
    s_waitcnt lgkmcnt(4)
    v_mfma_f32_16x16x32_bf16 v[44:47], v[96:99], v[156:159], v[44:47]
    v_mfma_f32_16x16x32_bf16 v[48:51], v[96:99], v[160:163], v[48:51]
    ds_read_b128 v[116:119], v3 offset:37888
    s_waitcnt lgkmcnt(4)
    v_mfma_f32_16x16x32_bf16 v[52:55], v[100:103], v[156:159], v[52:55]
    v_mfma_f32_16x16x32_bf16 v[56:59], v[100:103], v[160:163], v[56:59]
    buffer_load_dwordx4 v[192:195], v11, s[60:63], s100 offen sc1
    ds_read_b128 v[120:123], v3 offset:38912
    s_waitcnt lgkmcnt(4)
    v_mfma_f32_16x16x32_bf16 v[60:63], v[104:107], v[156:159], v[60:63]
    v_mfma_f32_16x16x32_bf16 v[64:67], v[104:107], v[160:163], v[64:67]
    s_waitcnt vmcnt(6)
    ds_read_b128 v[92:95], v3 offset:43008
    s_waitcnt lgkmcnt(4)
    v_mfma_f32_16x16x32_bf16 v[36:39], v[108:111], v[164:167], v[36:39]
    v_mfma_f32_16x16x32_bf16 v[40:43], v[108:111], v[168:171], v[40:43]
    s_add_u32 s100, s98, 9
    s_and_b32 s100, s100, 15
    s_lshl_b32 s100, s100, 10
    buffer_load_dwordx4 v[196:199], v10, s[60:63], s100 offen sc1
    ds_read_b128 v[96:99], v3 offset:44032
    s_waitcnt lgkmcnt(4)
    v_mfma_f32_16x16x32_bf16 v[44:47], v[112:115], v[164:167], v[44:47]
    v_mfma_f32_16x16x32_bf16 v[48:51], v[112:115], v[168:171], v[48:51]
    ds_read_b128 v[100:103], v3 offset:45056
    s_waitcnt lgkmcnt(4)
    v_mfma_f32_16x16x32_bf16 v[52:55], v[116:119], v[164:167], v[52:55]
    v_mfma_f32_16x16x32_bf16 v[56:59], v[116:119], v[168:171], v[56:59]
    buffer_load_dwordx4 v[200:203], v11, s[60:63], s100 offen sc1
    ds_read_b128 v[104:107], v3 offset:46080
    s_waitcnt lgkmcnt(4)
    v_mfma_f32_16x16x32_bf16 v[60:63], v[120:123], v[164:167], v[60:63]
    v_mfma_f32_16x16x32_bf16 v[64:67], v[120:123], v[168:171], v[64:67]
    s_waitcnt vmcnt(6)
    ds_read_b128 v[108:111], v3 offset:50176
    s_waitcnt lgkmcnt(4)
    v_mfma_f32_16x16x32_bf16 v[36:39], v[92:95], v[172:175], v[36:39]
    v_mfma_f32_16x16x32_bf16 v[40:43], v[92:95], v[176:179], v[40:43]
    s_add_u32 s100, s98, 10
    s_and_b32 s100, s100, 15
    s_lshl_b32 s100, s100, 10
    buffer_load_dwordx4 v[204:207], v10, s[60:63], s100 offen sc1
    ds_read_b128 v[112:115], v3 offset:51200
    s_waitcnt lgkmcnt(4)
    v_mfma_f32_16x16x32_bf16 v[44:47], v[96:99], v[172:175], v[44:47]
    v_mfma_f32_16x16x32_bf16 v[48:51], v[96:99], v[176:179], v[48:51]
    ds_read_b128 v[116:119], v3 offset:52224
    s_waitcnt lgkmcnt(4)
    v_mfma_f32_16x16x32_bf16 v[52:55], v[100:103], v[172:175], v[52:55]
    v_mfma_f32_16x16x32_bf16 v[56:59], v[100:103], v[176:179], v[56:59]
    buffer_load_dwordx4 v[208:211], v11, s[60:63], s100 offen sc1
    ds_read_b128 v[120:123], v3 offset:53248
    s_waitcnt lgkmcnt(4)
    v_mfma_f32_16x16x32_bf16 v[60:63], v[104:107], v[172:175], v[60:63]
    v_mfma_f32_16x16x32_bf16 v[64:67], v[104:107], v[176:179], v[64:67]
    s_waitcnt vmcnt(6)
    ds_read_b128 v[92:95], v24 offset:0
    s_waitcnt lgkmcnt(4)
    v_mfma_f32_16x16x32_bf16 v[36:39], v[108:111], v[180:183], v[36:39]
    v_mfma_f32_16x16x32_bf16 v[40:43], v[108:111], v[184:187], v[40:43]
    s_add_u32 s100, s98, 11
    s_and_b32 s100, s100, 15
    s_lshl_b32 s100, s100, 10
    buffer_load_dwordx4 v[212:215], v10, s[60:63], s100 offen sc1
    ds_read_b128 v[96:99], v24 offset:1024
    s_waitcnt lgkmcnt(4)
    v_mfma_f32_16x16x32_bf16 v[44:47], v[112:115], v[180:183], v[44:47]
    v_mfma_f32_16x16x32_bf16 v[48:51], v[112:115], v[184:187], v[48:51]
    ds_read_b128 v[100:103], v24 offset:2048
    s_waitcnt lgkmcnt(4)
    v_mfma_f32_16x16x32_bf16 v[52:55], v[116:119], v[180:183], v[52:55]
    v_mfma_f32_16x16x32_bf16 v[56:59], v[116:119], v[184:187], v[56:59]
    buffer_load_dwordx4 v[216:219], v11, s[60:63], s100 offen sc1
    ds_read_b128 v[104:107], v24 offset:3072
    s_waitcnt lgkmcnt(4)
    v_mfma_f32_16x16x32_bf16 v[60:63], v[120:123], v[180:183], v[60:63]
    v_mfma_f32_16x16x32_bf16 v[64:67], v[120:123], v[184:187], v[64:67]
    s_waitcnt vmcnt(6)
    ds_read_b128 v[108:111], v24 offset:7168
    s_waitcnt lgkmcnt(4)
    v_mfma_f32_16x16x32_bf16 v[36:39], v[92:95], v[188:191], v[36:39]
    v_mfma_f32_16x16x32_bf16 v[40:43], v[92:95], v[192:195], v[40:43]
    s_add_u32 s100, s98, 12
    s_and_b32 s100, s100, 15
    s_lshl_b32 s100, s100, 10
    buffer_load_dwordx4 v[220:223], v10, s[60:63], s100 offen sc1
    ds_read_b128 v[112:115], v24 offset:8192
    s_waitcnt lgkmcnt(4)
    v_mfma_f32_16x16x32_bf16 v[44:47], v[96:99], v[188:191], v[44:47]
    v_mfma_f32_16x16x32_bf16 v[48:51], v[96:99], v[192:195], v[48:51]
    ds_read_b128 v[116:119], v24 offset:9216
    s_waitcnt lgkmcnt(4)
    v_mfma_f32_16x16x32_bf16 v[52:55], v[100:103], v[188:191], v[52:55]
    v_mfma_f32_16x16x32_bf16 v[56:59], v[100:103], v[192:195], v[56:59]
    buffer_load_dwordx4 v[224:227], v11, s[60:63], s100 offen sc1
    ds_read_b128 v[120:123], v24 offset:10240
    s_waitcnt lgkmcnt(4)
    v_mfma_f32_16x16x32_bf16 v[60:63], v[104:107], v[188:191], v[60:63]
    v_mfma_f32_16x16x32_bf16 v[64:67], v[104:107], v[192:195], v[64:67]
    s_waitcnt vmcnt(6)
    ds_read_b128 v[92:95], v24 offset:14336
    s_waitcnt lgkmcnt(4)
    v_mfma_f32_16x16x32_bf16 v[36:39], v[108:111], v[196:199], v[36:39]
    v_mfma_f32_16x16x32_bf16 v[40:43], v[108:111], v[200:203], v[40:43]
    s_add_u32 s100, s98, 13
    s_and_b32 s100, s100, 15
    s_lshl_b32 s100, s100, 10
    buffer_load_dwordx4 v[228:231], v10, s[60:63], s100 offen sc1
    ds_read_b128 v[96:99], v24 offset:15360
    s_waitcnt lgkmcnt(4)
    v_mfma_f32_16x16x32_bf16 v[44:47], v[112:115], v[196:199], v[44:47]
    v_mfma_f32_16x16x32_bf16 v[48:51], v[112:115], v[200:203], v[48:51]
    ds_read_b128 v[100:103], v24 offset:16384
    s_waitcnt lgkmcnt(4)
    v_mfma_f32_16x16x32_bf16 v[52:55], v[116:119], v[196:199], v[52:55]
    v_mfma_f32_16x16x32_bf16 v[56:59], v[116:119], v[200:203], v[56:59]
    buffer_load_dwordx4 v[232:235], v11, s[60:63], s100 offen sc1
    ds_read_b128 v[104:107], v24 offset:17408
    s_waitcnt lgkmcnt(4)
    v_mfma_f32_16x16x32_bf16 v[60:63], v[120:123], v[196:199], v[60:63]
    v_mfma_f32_16x16x32_bf16 v[64:67], v[120:123], v[200:203], v[64:67]
    s_waitcnt vmcnt(6)
    ds_read_b128 v[108:111], v24 offset:21504
    s_waitcnt lgkmcnt(4)
    v_mfma_f32_16x16x32_bf16 v[36:39], v[92:95], v[204:207], v[36:39]
    v_mfma_f32_16x16x32_bf16 v[40:43], v[92:95], v[208:211], v[40:43]
    s_add_u32 s100, s98, 14
    s_and_b32 s100, s100, 15
    s_lshl_b32 s100, s100, 10
    buffer_load_dwordx4 v[236:239], v10, s[60:63], s100 offen sc1
    ds_read_b128 v[112:115], v24 offset:22528
    s_waitcnt lgkmcnt(4)
    v_mfma_f32_16x16x32_bf16 v[44:47], v[96:99], v[204:207], v[44:47]
    v_mfma_f32_16x16x32_bf16 v[48:51], v[96:99], v[208:211], v[48:51]
    ds_read_b128 v[116:119], v24 offset:23552
    s_waitcnt lgkmcnt(4)
    v_mfma_f32_16x16x32_bf16 v[52:55], v[100:103], v[204:207], v[52:55]
    v_mfma_f32_16x16x32_bf16 v[56:59], v[100:103], v[208:211], v[56:59]
    buffer_load_dwordx4 v[240:243], v11, s[60:63], s100 offen sc1
    ds_read_b128 v[120:123], v24 offset:24576
    s_waitcnt lgkmcnt(4)
    v_mfma_f32_16x16x32_bf16 v[60:63], v[104:107], v[204:207], v[60:63]
    v_mfma_f32_16x16x32_bf16 v[64:67], v[104:107], v[208:211], v[64:67]
    s_waitcnt vmcnt(6)
    ds_read_b128 v[92:95], v24 offset:28672
    s_waitcnt lgkmcnt(4)
    v_mfma_f32_16x16x32_bf16 v[36:39], v[108:111], v[212:215], v[36:39]
    v_mfma_f32_16x16x32_bf16 v[40:43], v[108:111], v[216:219], v[40:43]
    s_add_u32 s100, s98, 15
    s_and_b32 s100, s100, 15
    s_lshl_b32 s100, s100, 10
    buffer_load_dwordx4 v[244:247], v10, s[60:63], s100 offen sc1
    ds_read_b128 v[96:99], v24 offset:29696
    s_waitcnt lgkmcnt(4)
    v_mfma_f32_16x16x32_bf16 v[44:47], v[112:115], v[212:215], v[44:47]
    v_mfma_f32_16x16x32_bf16 v[48:51], v[112:115], v[216:219], v[48:51]
    ds_read_b128 v[100:103], v24 offset:30720
    s_waitcnt lgkmcnt(4)
    v_mfma_f32_16x16x32_bf16 v[52:55], v[116:119], v[212:215], v[52:55]
    v_mfma_f32_16x16x32_bf16 v[56:59], v[116:119], v[216:219], v[56:59]
    buffer_load_dwordx4 v[248:251], v11, s[60:63], s100 offen sc1
    ds_read_b128 v[104:107], v24 offset:31744
    s_waitcnt lgkmcnt(4)
    v_mfma_f32_16x16x32_bf16 v[60:63], v[120:123], v[212:215], v[60:63]
    v_mfma_f32_16x16x32_bf16 v[64:67], v[120:123], v[216:219], v[64:67]
    s_waitcnt vmcnt(6)
    ds_read_b128 v[108:111], v24 offset:35840
    s_waitcnt lgkmcnt(4)
    v_mfma_f32_16x16x32_bf16 v[36:39], v[92:95], v[220:223], v[36:39]
    v_mfma_f32_16x16x32_bf16 v[40:43], v[92:95], v[224:227], v[40:43]
    ds_read_b128 v[112:115], v24 offset:36864
    s_waitcnt lgkmcnt(4)
    v_mfma_f32_16x16x32_bf16 v[44:47], v[96:99], v[220:223], v[44:47]
    v_mfma_f32_16x16x32_bf16 v[48:51], v[96:99], v[224:227], v[48:51]
    ds_read_b128 v[116:119], v24 offset:37888
    s_waitcnt lgkmcnt(4)
    v_mfma_f32_16x16x32_bf16 v[52:55], v[100:103], v[220:223], v[52:55]
    v_mfma_f32_16x16x32_bf16 v[56:59], v[100:103], v[224:227], v[56:59]
    ds_read_b128 v[120:123], v24 offset:38912
    s_waitcnt lgkmcnt(4)
    v_mfma_f32_16x16x32_bf16 v[60:63], v[104:107], v[220:223], v[60:63]
    v_mfma_f32_16x16x32_bf16 v[64:67], v[104:107], v[224:227], v[64:67]
    buffer_load_dwordx2 v[68:69], v12, s[56:59], 0 offen offset:0 sc1
    buffer_load_dwordx2 v[70:71], v12, s[56:59], 0 offen offset:128 sc1
    buffer_load_dwordx2 v[72:73], v12, s[56:59], 0 offen offset:256 sc1
    buffer_load_dwordx2 v[74:75], v12, s[56:59], 0 offen offset:384 sc1
    buffer_load_dwordx2 v[76:77], v12, s[56:59], 0 offen offset:2048 sc1
    buffer_load_dwordx2 v[78:79], v12, s[56:59], 0 offen offset:2176 sc1
    buffer_load_dwordx2 v[80:81], v12, s[56:59], 0 offen offset:2304 sc1
    buffer_load_dwordx2 v[82:83], v12, s[56:59], 0 offen offset:2432 sc1
    s_waitcnt vmcnt(12)
    ds_read_b128 v[92:95], v24 offset:43008
    s_waitcnt lgkmcnt(4)
    v_mfma_f32_16x16x32_bf16 v[36:39], v[108:111], v[228:231], v[36:39]
    v_mfma_f32_16x16x32_bf16 v[40:43], v[108:111], v[232:235], v[40:43]
    ds_read_b128 v[96:99], v24 offset:44032
    s_waitcnt lgkmcnt(4)
    v_mfma_f32_16x16x32_bf16 v[44:47], v[112:115], v[228:231], v[44:47]
    v_mfma_f32_16x16x32_bf16 v[48:51], v[112:115], v[232:235], v[48:51]
    ds_read_b128 v[100:103], v24 offset:45056
    s_waitcnt lgkmcnt(4)
    v_mfma_f32_16x16x32_bf16 v[52:55], v[116:119], v[228:231], v[52:55]
    v_mfma_f32_16x16x32_bf16 v[56:59], v[116:119], v[232:235], v[56:59]
    ds_read_b128 v[104:107], v24 offset:46080
    s_waitcnt lgkmcnt(4)
    v_mfma_f32_16x16x32_bf16 v[60:63], v[120:123], v[228:231], v[60:63]
    v_mfma_f32_16x16x32_bf16 v[64:67], v[120:123], v[232:235], v[64:67]
    s_waitcnt vmcnt(10)
    ds_read_b128 v[108:111], v24 offset:50176
    s_waitcnt lgkmcnt(4)
    v_mfma_f32_16x16x32_bf16 v[36:39], v[92:95], v[236:239], v[36:39]
    v_mfma_f32_16x16x32_bf16 v[40:43], v[92:95], v[240:243], v[40:43]
    ds_read_b128 v[112:115], v24 offset:51200
    s_waitcnt lgkmcnt(4)
    v_mfma_f32_16x16x32_bf16 v[44:47], v[96:99], v[236:239], v[44:47]
    v_mfma_f32_16x16x32_bf16 v[48:51], v[96:99], v[240:243], v[48:51]
    ds_read_b128 v[116:119], v24 offset:52224
    s_waitcnt lgkmcnt(4)
    v_mfma_f32_16x16x32_bf16 v[52:55], v[100:103], v[236:239], v[52:55]
    v_mfma_f32_16x16x32_bf16 v[56:59], v[100:103], v[240:243], v[56:59]
    ds_read_b128 v[120:123], v24 offset:53248
    s_waitcnt lgkmcnt(4)
    v_mfma_f32_16x16x32_bf16 v[60:63], v[104:107], v[236:239], v[60:63]
    v_mfma_f32_16x16x32_bf16 v[64:67], v[104:107], v[240:243], v[64:67]
    s_waitcnt vmcnt(8)
    s_waitcnt lgkmcnt(3)
    v_mfma_f32_16x16x32_bf16 v[36:39], v[108:111], v[244:247], v[36:39]
    v_mfma_f32_16x16x32_bf16 v[40:43], v[108:111], v[248:251], v[40:43]
    s_waitcnt lgkmcnt(2)
    v_mfma_f32_16x16x32_bf16 v[44:47], v[112:115], v[244:247], v[44:47]
    v_mfma_f32_16x16x32_bf16 v[48:51], v[112:115], v[248:251], v[48:51]
    s_waitcnt lgkmcnt(1)
    v_mfma_f32_16x16x32_bf16 v[52:55], v[116:119], v[244:247], v[52:55]
    v_mfma_f32_16x16x32_bf16 v[56:59], v[116:119], v[248:251], v[56:59]
    s_waitcnt lgkmcnt(0)
    v_mfma_f32_16x16x32_bf16 v[60:63], v[120:123], v[244:247], v[60:63]
    v_mfma_f32_16x16x32_bf16 v[64:67], v[120:123], v[248:251], v[64:67]
    s_waitcnt vmcnt(0)
    v_pk_add_f32 v[68:69], v[68:69], v[70:71]
    v_pk_add_f32 v[72:73], v[72:73], v[74:75]
    v_pk_add_f32 v[68:69], v[68:69], v[72:73]
    v_pk_add_f32 v[76:77], v[76:77], v[78:79]
    v_pk_add_f32 v[80:81], v[80:81], v[82:83]
    v_pk_add_f32 v[76:77], v[76:77], v[80:81]
    ds_read_b128 v[92:95], v13 offset:0
    ds_read_b128 v[96:99], v13 offset:448
    ds_read_b128 v[100:103], v13 offset:896
    ds_read_b128 v[104:107], v13 offset:1344
    ds_read_b128 v[108:111], v13 offset:64
    ds_read_b128 v[112:115], v13 offset:512
    ds_read_b128 v[116:119], v13 offset:960
    ds_read_b128 v[120:123], v13 offset:1408
    v_mov_b32 v70, v68
    v_mov_b32 v71, v69
    v_mov_b32 v78, v76
    v_mov_b32 v79, v77
    s_nop 1
    v_permlane32_swap_b32 v68, v70
    v_permlane32_swap_b32 v69, v71
    v_permlane32_swap_b32 v76, v78
    v_permlane32_swap_b32 v77, v79
    s_nop 0
    v_add_f32 v68, v68, v70
    v_add_f32 v69, v69, v71
    v_add_f32 v76, v76, v78
    v_add_f32 v77, v77, v79
    v_mov_b32 v70, v68
    v_mov_b32 v71, v69
    v_mov_b32 v78, v76
    v_mov_b32 v79, v77
    s_nop 1
    v_permlane16_swap_b32 v68, v70
    v_permlane16_swap_b32 v69, v71
    v_permlane16_swap_b32 v76, v78
    v_permlane16_swap_b32 v77, v79
    s_nop 0
    v_add_f32 v68, v68, v70
    v_add_f32 v69, v69, v71
    v_add_f32 v76, v76, v78
    v_add_f32 v77, v77, v79
    v_mul_f32 v16, 0xbb000000, v68
    v_mul_f32 v69, 0x3b000000, v69
    v_fma_f32 v69, -v16, v16, v69
    v_max_f32 v69, 0, v69
    v_add_f32 v69, 0x3727c5ac, v69
    v_rsq_f32 v20, v69
    v_mov_b32 v17, v16
    v_mul_f32 v18, 0xbb000000, v76
    v_mul_f32 v77, 0x3b000000, v77
    v_fma_f32 v77, -v18, v18, v77
    v_max_f32 v77, 0, v77
    v_add_f32 v77, 0x3727c5ac, v77
    v_rsq_f32 v22, v77
    v_mov_b32 v19, v18
    v_mov_b32 v21, v20
    v_mov_b32 v23, v22
    s_waitcnt lgkmcnt(0)
    v_pk_add_f32 v[92:93], v[92:93], v[96:97]
    v_pk_add_f32 v[100:101], v[100:101], v[104:105]
    v_pk_add_f32 v[92:93], v[92:93], v[100:101]
    v_pk_add_f32 v[94:95], v[94:95], v[98:99]
    v_pk_add_f32 v[102:103], v[102:103], v[106:107]
    v_pk_add_f32 v[94:95], v[94:95], v[102:103]
    v_pk_add_f32 v[108:109], v[108:109], v[112:113]
    v_pk_add_f32 v[116:117], v[116:117], v[120:121]
    v_pk_add_f32 v[108:109], v[108:109], v[116:117]
    v_pk_add_f32 v[110:111], v[110:111], v[114:115]
    v_pk_add_f32 v[118:119], v[118:119], v[122:123]
    v_pk_add_f32 v[110:111], v[110:111], v[118:119]
    v_mov_b32 v68, v92
    v_mov_b32 v69, v93
    v_mov_b32 v70, v94
    v_mov_b32 v71, v95
    v_mov_b32 v72, v108
    v_mov_b32 v73, v109
    v_mov_b32 v74, v110
    v_mov_b32 v75, v111
    ds_read_b128 v[92:95], v13 offset:128
    ds_read_b128 v[96:99], v13 offset:576
    ds_read_b128 v[100:103], v13 offset:1024
    ds_read_b128 v[104:107], v13 offset:1472
    ds_read_b128 v[108:111], v13 offset:192
    ds_read_b128 v[112:115], v13 offset:640
    ds_read_b128 v[116:119], v13 offset:1088
    ds_read_b128 v[120:123], v13 offset:1536
    v_pk_fma_f32 v[36:37], v[16:17], v[68:69], v[36:37]
    v_pk_fma_f32 v[38:39], v[16:17], v[70:71], v[38:39]
    v_pk_mul_f32 v[36:37], v[36:37], v[20:21]
    v_pk_mul_f32 v[38:39], v[38:39], v[20:21]
    v_cvt_pk_bf16_f32 v76, v36, v37
    v_cvt_pk_bf16_f32 v77, v38, v39
    v_pk_max_i16 v76, v76, 0
    v_pk_max_i16 v77, v77, 0
    v_pk_fma_f32 v[44:45], v[16:17], v[72:73], v[44:45]
    v_pk_fma_f32 v[46:47], v[16:17], v[74:75], v[46:47]
    v_pk_mul_f32 v[44:45], v[44:45], v[20:21]
    v_pk_mul_f32 v[46:47], v[46:47], v[20:21]
    v_cvt_pk_bf16_f32 v78, v44, v45
    v_cvt_pk_bf16_f32 v79, v46, v47
    v_pk_max_i16 v78, v78, 0
    v_pk_max_i16 v79, v79, 0
    buffer_store_dwordx4 v[76:79], v8, s[64:67], 0 offen offset:0 sc1
    v_pk_fma_f32 v[40:41], v[18:19], v[68:69], v[40:41]
    v_pk_fma_f32 v[42:43], v[18:19], v[70:71], v[42:43]
    v_pk_mul_f32 v[40:41], v[40:41], v[22:23]
    v_pk_mul_f32 v[42:43], v[42:43], v[22:23]
    v_cvt_pk_bf16_f32 v80, v40, v41
    v_cvt_pk_bf16_f32 v81, v42, v43
    v_pk_max_i16 v80, v80, 0
    v_pk_max_i16 v81, v81, 0
    v_pk_fma_f32 v[48:49], v[18:19], v[72:73], v[48:49]
    v_pk_fma_f32 v[50:51], v[18:19], v[74:75], v[50:51]
    v_pk_mul_f32 v[48:49], v[48:49], v[22:23]
    v_pk_mul_f32 v[50:51], v[50:51], v[22:23]
    v_cvt_pk_bf16_f32 v82, v48, v49
    v_cvt_pk_bf16_f32 v83, v50, v51
    v_pk_max_i16 v82, v82, 0
    v_pk_max_i16 v83, v83, 0
    buffer_store_dwordx4 v[80:83], v8, s[64:67], s90 offen offset:0 sc1
    s_waitcnt lgkmcnt(0)
    v_pk_add_f32 v[92:93], v[92:93], v[96:97]
    v_pk_add_f32 v[100:101], v[100:101], v[104:105]
    v_pk_add_f32 v[92:93], v[92:93], v[100:101]
    v_pk_add_f32 v[94:95], v[94:95], v[98:99]
    v_pk_add_f32 v[102:103], v[102:103], v[106:107]
    v_pk_add_f32 v[94:95], v[94:95], v[102:103]
    v_pk_add_f32 v[108:109], v[108:109], v[112:113]
    v_pk_add_f32 v[116:117], v[116:117], v[120:121]
    v_pk_add_f32 v[108:109], v[108:109], v[116:117]
    v_pk_add_f32 v[110:111], v[110:111], v[114:115]
    v_pk_add_f32 v[118:119], v[118:119], v[122:123]
    v_pk_add_f32 v[110:111], v[110:111], v[118:119]
    v_pk_fma_f32 v[52:53], v[16:17], v[92:93], v[52:53]
    v_pk_fma_f32 v[54:55], v[16:17], v[94:95], v[54:55]
    v_pk_mul_f32 v[52:53], v[52:53], v[20:21]
    v_pk_mul_f32 v[54:55], v[54:55], v[20:21]
    v_cvt_pk_bf16_f32 v36, v52, v53
    v_cvt_pk_bf16_f32 v37, v54, v55
    v_pk_max_i16 v36, v36, 0
    v_pk_max_i16 v37, v37, 0
    v_pk_fma_f32 v[60:61], v[16:17], v[108:109], v[60:61]
    v_pk_fma_f32 v[62:63], v[16:17], v[110:111], v[62:63]
    v_pk_mul_f32 v[60:61], v[60:61], v[20:21]
    v_pk_mul_f32 v[62:63], v[62:63], v[20:21]
    v_cvt_pk_bf16_f32 v38, v60, v61
    v_cvt_pk_bf16_f32 v39, v62, v63
    v_pk_max_i16 v38, v38, 0
    v_pk_max_i16 v39, v39, 0
    buffer_store_dwordx4 v[36:39], v8, s[64:67], 0 offen offset:1024 sc1
    v_pk_fma_f32 v[56:57], v[18:19], v[92:93], v[56:57]
    v_pk_fma_f32 v[58:59], v[18:19], v[94:95], v[58:59]
    v_pk_mul_f32 v[56:57], v[56:57], v[22:23]
    v_pk_mul_f32 v[58:59], v[58:59], v[22:23]
    v_cvt_pk_bf16_f32 v40, v56, v57
    v_cvt_pk_bf16_f32 v41, v58, v59
    v_pk_max_i16 v40, v40, 0
    v_pk_max_i16 v41, v41, 0
    v_pk_fma_f32 v[64:65], v[18:19], v[108:109], v[64:65]
    v_pk_fma_f32 v[66:67], v[18:19], v[110:111], v[66:67]
    v_pk_mul_f32 v[64:65], v[64:65], v[22:23]
    v_pk_mul_f32 v[66:67], v[66:67], v[22:23]
    v_cvt_pk_bf16_f32 v42, v64, v65
    v_cvt_pk_bf16_f32 v43, v66, v67
    v_pk_max_i16 v42, v42, 0
    v_pk_max_i16 v43, v43, 0
    buffer_store_dwordx4 v[40:43], v8, s[64:67], s90 offen offset:1024 sc1
    ds_read_b128 v[92:95], v3 offset:4096
    ds_read_b128 v[96:99], v3 offset:5120
    ds_read_b128 v[100:103], v3 offset:6144
    ds_read_b128 v[108:111], v3 offset:11264
    s_waitcnt lgkmcnt(3)
    v_mfma_f32_16x16x32_bf16 v[68:71], v[92:95], v[124:127], 0
    v_mfma_f32_16x16x32_bf16 v[72:75], v[92:95], v[128:131], 0
    ds_read_b128 v[112:115], v3 offset:12288
    s_waitcnt lgkmcnt(3)
    v_mfma_f32_16x16x32_bf16 v[76:79], v[96:99], v[124:127], 0
    v_mfma_f32_16x16x32_bf16 v[80:83], v[96:99], v[128:131], 0
    ds_read_b128 v[116:119], v3 offset:13312
    s_waitcnt lgkmcnt(3)
    v_mfma_f32_16x16x32_bf16 v[84:87], v[100:103], v[124:127], 0
    v_mfma_f32_16x16x32_bf16 v[88:91], v[100:103], v[128:131], 0
    ds_read_b128 v[92:95], v3 offset:18432
    s_waitcnt lgkmcnt(3)
    v_mfma_f32_16x16x32_bf16 v[68:71], v[108:111], v[132:135], v[68:71]
    v_mfma_f32_16x16x32_bf16 v[72:75], v[108:111], v[136:139], v[72:75]
    ds_read_b128 v[96:99], v3 offset:19456
    s_waitcnt lgkmcnt(3)
    v_mfma_f32_16x16x32_bf16 v[76:79], v[112:115], v[132:135], v[76:79]
    v_mfma_f32_16x16x32_bf16 v[80:83], v[112:115], v[136:139], v[80:83]
    ds_read_b128 v[100:103], v3 offset:20480
    s_waitcnt lgkmcnt(3)
    v_mfma_f32_16x16x32_bf16 v[84:87], v[116:119], v[132:135], v[84:87]
    v_mfma_f32_16x16x32_bf16 v[88:91], v[116:119], v[136:139], v[88:91]
    ds_read_b128 v[108:111], v3 offset:25600
    s_waitcnt lgkmcnt(3)
    v_mfma_f32_16x16x32_bf16 v[68:71], v[92:95], v[140:143], v[68:71]
    v_mfma_f32_16x16x32_bf16 v[72:75], v[92:95], v[144:147], v[72:75]
    ds_read_b128 v[112:115], v3 offset:26624
    s_waitcnt lgkmcnt(3)
    v_mfma_f32_16x16x32_bf16 v[76:79], v[96:99], v[140:143], v[76:79]
    v_mfma_f32_16x16x32_bf16 v[80:83], v[96:99], v[144:147], v[80:83]
    ds_read_b128 v[116:119], v3 offset:27648
    s_waitcnt lgkmcnt(3)
    v_mfma_f32_16x16x32_bf16 v[84:87], v[100:103], v[140:143], v[84:87]
    v_mfma_f32_16x16x32_bf16 v[88:91], v[100:103], v[144:147], v[88:91]
    ds_read_b128 v[92:95], v3 offset:32768
    s_waitcnt lgkmcnt(3)
    v_mfma_f32_16x16x32_bf16 v[68:71], v[108:111], v[148:151], v[68:71]
    v_mfma_f32_16x16x32_bf16 v[72:75], v[108:111], v[152:155], v[72:75]
    ds_read_b128 v[96:99], v3 offset:33792
    s_waitcnt lgkmcnt(3)
    v_mfma_f32_16x16x32_bf16 v[76:79], v[112:115], v[148:151], v[76:79]
    v_mfma_f32_16x16x32_bf16 v[80:83], v[112:115], v[152:155], v[80:83]
    ds_read_b128 v[100:103], v3 offset:34816
    s_waitcnt lgkmcnt(3)
    v_mfma_f32_16x16x32_bf16 v[84:87], v[116:119], v[148:151], v[84:87]
    v_mfma_f32_16x16x32_bf16 v[88:91], v[116:119], v[152:155], v[88:91]
    ds_read_b128 v[108:111], v3 offset:39936
    s_waitcnt lgkmcnt(3)
    v_mfma_f32_16x16x32_bf16 v[68:71], v[92:95], v[156:159], v[68:71]
    v_mfma_f32_16x16x32_bf16 v[72:75], v[92:95], v[160:163], v[72:75]
    ds_read_b128 v[112:115], v3 offset:40960
    s_waitcnt lgkmcnt(3)
    v_mfma_f32_16x16x32_bf16 v[76:79], v[96:99], v[156:159], v[76:79]
    v_mfma_f32_16x16x32_bf16 v[80:83], v[96:99], v[160:163], v[80:83]
    ds_read_b128 v[116:119], v3 offset:41984
    s_waitcnt lgkmcnt(3)
    v_mfma_f32_16x16x32_bf16 v[84:87], v[100:103], v[156:159], v[84:87]
    v_mfma_f32_16x16x32_bf16 v[88:91], v[100:103], v[160:163], v[88:91]
    ds_read_b128 v[92:95], v3 offset:47104
    s_waitcnt lgkmcnt(3)
    v_mfma_f32_16x16x32_bf16 v[68:71], v[108:111], v[164:167], v[68:71]
    v_mfma_f32_16x16x32_bf16 v[72:75], v[108:111], v[168:171], v[72:75]
    ds_read_b128 v[96:99], v3 offset:48128
    s_waitcnt lgkmcnt(3)
    v_mfma_f32_16x16x32_bf16 v[76:79], v[112:115], v[164:167], v[76:79]
    v_mfma_f32_16x16x32_bf16 v[80:83], v[112:115], v[168:171], v[80:83]
    ds_read_b128 v[100:103], v3 offset:49152
    s_waitcnt lgkmcnt(3)
    v_mfma_f32_16x16x32_bf16 v[84:87], v[116:119], v[164:167], v[84:87]
    v_mfma_f32_16x16x32_bf16 v[88:91], v[116:119], v[168:171], v[88:91]
    ds_read_b128 v[108:111], v3 offset:54272
    s_waitcnt lgkmcnt(3)
    v_mfma_f32_16x16x32_bf16 v[68:71], v[92:95], v[172:175], v[68:71]
    v_mfma_f32_16x16x32_bf16 v[72:75], v[92:95], v[176:179], v[72:75]
    ds_read_b128 v[112:115], v3 offset:55296
    s_waitcnt lgkmcnt(3)
    v_mfma_f32_16x16x32_bf16 v[76:79], v[96:99], v[172:175], v[76:79]
    v_mfma_f32_16x16x32_bf16 v[80:83], v[96:99], v[176:179], v[80:83]
    ds_read_b128 v[116:119], v3 offset:56320
    s_waitcnt lgkmcnt(3)
    v_mfma_f32_16x16x32_bf16 v[84:87], v[100:103], v[172:175], v[84:87]
    v_mfma_f32_16x16x32_bf16 v[88:91], v[100:103], v[176:179], v[88:91]
    s_waitcnt vmcnt(0)
    s_mov_b64 exec, 1
    ds_add_rtn_u32 v4, v14, v15 offset:28
    s_mov_b64 exec, -1
    s_waitcnt lgkmcnt(0)
    v_readfirstlane_b32 s76, v4
    s_nop 3
    s_cmp_lg_u32 s76, 3
    s_cbranch_scc1 L_ar3_skip
    s_mov_b64 exec, 1
    buffer_atomic_add v15, v31, s[52:55], 0 offen sc1
    s_mov_b64 exec, -1
L_ar3_skip:
    v_add_u32 v31, 4096, v31
    ds_read_b128 v[92:95], v24 offset:4096
    s_waitcnt lgkmcnt(3)
    v_mfma_f32_16x16x32_bf16 v[68:71], v[108:111], v[180:183], v[68:71]
    v_mfma_f32_16x16x32_bf16 v[72:75], v[108:111], v[184:187], v[72:75]
    ds_read_b128 v[96:99], v24 offset:5120
    s_waitcnt lgkmcnt(3)
    v_mfma_f32_16x16x32_bf16 v[76:79], v[112:115], v[180:183], v[76:79]
    v_mfma_f32_16x16x32_bf16 v[80:83], v[112:115], v[184:187], v[80:83]
    ds_read_b128 v[100:103], v24 offset:6144
    s_waitcnt lgkmcnt(3)
    v_mfma_f32_16x16x32_bf16 v[84:87], v[116:119], v[180:183], v[84:87]
    v_mfma_f32_16x16x32_bf16 v[88:91], v[116:119], v[184:187], v[88:91]
    ds_read_b128 v[108:111], v24 offset:11264
    s_waitcnt lgkmcnt(3)
    v_mfma_f32_16x16x32_bf16 v[68:71], v[92:95], v[188:191], v[68:71]
    v_mfma_f32_16x16x32_bf16 v[72:75], v[92:95], v[192:195], v[72:75]
    ds_read_b128 v[112:115], v24 offset:12288
    s_waitcnt lgkmcnt(3)
    v_mfma_f32_16x16x32_bf16 v[76:79], v[96:99], v[188:191], v[76:79]
    v_mfma_f32_16x16x32_bf16 v[80:83], v[96:99], v[192:195], v[80:83]
    ds_read_b128 v[116:119], v24 offset:13312
    s_waitcnt lgkmcnt(3)
    v_mfma_f32_16x16x32_bf16 v[84:87], v[100:103], v[188:191], v[84:87]
    v_mfma_f32_16x16x32_bf16 v[88:91], v[100:103], v[192:195], v[88:91]
    ds_read_b128 v[92:95], v24 offset:18432
    s_waitcnt lgkmcnt(3)
    v_mfma_f32_16x16x32_bf16 v[68:71], v[108:111], v[196:199], v[68:71]
    v_mfma_f32_16x16x32_bf16 v[72:75], v[108:111], v[200:203], v[72:75]
    ds_read_b128 v[96:99], v24 offset:19456
    s_waitcnt lgkmcnt(3)
    v_mfma_f32_16x16x32_bf16 v[76:79], v[112:115], v[196:199], v[76:79]
    v_mfma_f32_16x16x32_bf16 v[80:83], v[112:115], v[200:203], v[80:83]
    ds_read_b128 v[100:103], v24 offset:20480
    s_waitcnt lgkmcnt(3)
    v_mfma_f32_16x16x32_bf16 v[84:87], v[116:119], v[196:199], v[84:87]
    v_mfma_f32_16x16x32_bf16 v[88:91], v[116:119], v[200:203], v[88:91]
    ds_read_b128 v[108:111], v24 offset:25600
    s_waitcnt lgkmcnt(3)
    v_mfma_f32_16x16x32_bf16 v[68:71], v[92:95], v[204:207], v[68:71]
    v_mfma_f32_16x16x32_bf16 v[72:75], v[92:95], v[208:211], v[72:75]
    ds_read_b128 v[112:115], v24 offset:26624
    s_waitcnt lgkmcnt(3)
    v_mfma_f32_16x16x32_bf16 v[76:79], v[96:99], v[204:207], v[76:79]
    v_mfma_f32_16x16x32_bf16 v[80:83], v[96:99], v[208:211], v[80:83]
    ds_read_b128 v[116:119], v24 offset:27648
    s_waitcnt lgkmcnt(3)
    v_mfma_f32_16x16x32_bf16 v[84:87], v[100:103], v[204:207], v[84:87]
    v_mfma_f32_16x16x32_bf16 v[88:91], v[100:103], v[208:211], v[88:91]
    ds_read_b128 v[92:95], v24 offset:32768
    s_waitcnt lgkmcnt(3)
    v_mfma_f32_16x16x32_bf16 v[68:71], v[108:111], v[212:215], v[68:71]
    v_mfma_f32_16x16x32_bf16 v[72:75], v[108:111], v[216:219], v[72:75]
    ds_read_b128 v[96:99], v24 offset:33792
    s_waitcnt lgkmcnt(3)
    v_mfma_f32_16x16x32_bf16 v[76:79], v[112:115], v[212:215], v[76:79]
    v_mfma_f32_16x16x32_bf16 v[80:83], v[112:115], v[216:219], v[80:83]
    ds_read_b128 v[100:103], v24 offset:34816
    s_waitcnt lgkmcnt(3)
    v_mfma_f32_16x16x32_bf16 v[84:87], v[116:119], v[212:215], v[84:87]
    v_mfma_f32_16x16x32_bf16 v[88:91], v[116:119], v[216:219], v[88:91]
    ds_read_b128 v[108:111], v24 offset:39936
    s_waitcnt lgkmcnt(3)
    v_mfma_f32_16x16x32_bf16 v[68:71], v[92:95], v[220:223], v[68:71]
    v_mfma_f32_16x16x32_bf16 v[72:75], v[92:95], v[224:227], v[72:75]
    ds_read_b128 v[112:115], v24 offset:40960
    s_waitcnt lgkmcnt(3)
    v_mfma_f32_16x16x32_bf16 v[76:79], v[96:99], v[220:223], v[76:79]
    v_mfma_f32_16x16x32_bf16 v[80:83], v[96:99], v[224:227], v[80:83]
    ds_read_b128 v[116:119], v24 offset:41984
    s_waitcnt lgkmcnt(3)
    v_mfma_f32_16x16x32_bf16 v[84:87], v[100:103], v[220:223], v[84:87]
    v_mfma_f32_16x16x32_bf16 v[88:91], v[100:103], v[224:227], v[88:91]
    ds_read_b128 v[92:95], v24 offset:47104
    s_waitcnt lgkmcnt(3)
    v_mfma_f32_16x16x32_bf16 v[68:71], v[108:111], v[228:231], v[68:71]
    v_mfma_f32_16x16x32_bf16 v[72:75], v[108:111], v[232:235], v[72:75]
    ds_read_b128 v[96:99], v24 offset:48128
    s_waitcnt lgkmcnt(3)
    v_mfma_f32_16x16x32_bf16 v[76:79], v[112:115], v[228:231], v[76:79]
    v_mfma_f32_16x16x32_bf16 v[80:83], v[112:115], v[232:235], v[80:83]
    ds_read_b128 v[100:103], v24 offset:49152
    s_waitcnt lgkmcnt(3)
    v_mfma_f32_16x16x32_bf16 v[84:87], v[116:119], v[228:231], v[84:87]
    v_mfma_f32_16x16x32_bf16 v[88:91], v[116:119], v[232:235], v[88:91]
    ds_read_b128 v[108:111], v24 offset:54272
    s_waitcnt lgkmcnt(3)
    v_mfma_f32_16x16x32_bf16 v[68:71], v[92:95], v[236:239], v[68:71]
    v_mfma_f32_16x16x32_bf16 v[72:75], v[92:95], v[240:243], v[72:75]
    ds_read_b128 v[112:115], v24 offset:55296
    s_waitcnt lgkmcnt(3)
    v_mfma_f32_16x16x32_bf16 v[76:79], v[96:99], v[236:239], v[76:79]
    v_mfma_f32_16x16x32_bf16 v[80:83], v[96:99], v[240:243], v[80:83]
    ds_read_b128 v[116:119], v24 offset:56320
    s_waitcnt lgkmcnt(3)
    v_mfma_f32_16x16x32_bf16 v[84:87], v[100:103], v[236:239], v[84:87]
    v_mfma_f32_16x16x32_bf16 v[88:91], v[100:103], v[240:243], v[88:91]
    s_waitcnt lgkmcnt(2)
    v_mfma_f32_16x16x32_bf16 v[68:71], v[108:111], v[244:247], v[68:71]
    v_mfma_f32_16x16x32_bf16 v[72:75], v[108:111], v[248:251], v[72:75]
    s_waitcnt lgkmcnt(1)
    v_mfma_f32_16x16x32_bf16 v[76:79], v[112:115], v[244:247], v[76:79]
    v_mfma_f32_16x16x32_bf16 v[80:83], v[112:115], v[248:251], v[80:83]
    s_waitcnt lgkmcnt(0)
    v_mfma_f32_16x16x32_bf16 v[84:87], v[116:119], v[244:247], v[84:87]
    v_mfma_f32_16x16x32_bf16 v[88:91], v[116:119], v[248:251], v[88:91]
    ds_read_b128 v[124:127], v13 offset:256
    ds_read_b128 v[128:131], v13 offset:704
    ds_read_b128 v[132:135], v13 offset:1152
    ds_read_b128 v[136:139], v13 offset:1600
    ds_read_b128 v[140:143], v13 offset:320
    ds_read_b128 v[144:147], v13 offset:768
    ds_read_b128 v[148:151], v13 offset:1216
    ds_read_b128 v[152:155], v13 offset:1664
    ds_read_b128 v[156:159], v13 offset:384
    ds_read_b128 v[160:163], v13 offset:832
    ds_read_b128 v[164:167], v13 offset:1280
    ds_read_b128 v[168:171], v13 offset:1728
    s_waitcnt lgkmcnt(0)
    s_mov_b64 exec, 1
    ds_add_u32 v14, v15 offset:12
    s_mov_b64 exec, -1
    v_pk_add_f32 v[124:125], v[124:125], v[128:129]
    v_pk_add_f32 v[132:133], v[132:133], v[136:137]
    v_pk_add_f32 v[124:125], v[124:125], v[132:133]
    v_pk_add_f32 v[126:127], v[126:127], v[130:131]
    v_pk_add_f32 v[134:135], v[134:135], v[138:139]
    v_pk_add_f32 v[126:127], v[126:127], v[134:135]
    v_pk_add_f32 v[140:141], v[140:141], v[144:145]
    v_pk_add_f32 v[148:149], v[148:149], v[152:153]
    v_pk_add_f32 v[140:141], v[140:141], v[148:149]
    v_pk_add_f32 v[142:143], v[142:143], v[146:147]
    v_pk_add_f32 v[150:151], v[150:151], v[154:155]
    v_pk_add_f32 v[142:143], v[142:143], v[150:151]
    v_pk_add_f32 v[156:157], v[156:157], v[160:161]
    v_pk_add_f32 v[164:165], v[164:165], v[168:169]
    v_pk_add_f32 v[156:157], v[156:157], v[164:165]
    v_pk_add_f32 v[158:159], v[158:159], v[162:163]
    v_pk_add_f32 v[166:167], v[166:167], v[170:171]
    v_pk_add_f32 v[158:159], v[158:159], v[166:167]
    v_pk_fma_f32 v[68:69], v[16:17], v[124:125], v[68:69]
    v_pk_fma_f32 v[70:71], v[16:17], v[126:127], v[70:71]
    v_pk_mul_f32 v[68:69], v[68:69], v[20:21]
    v_pk_mul_f32 v[70:71], v[70:71], v[20:21]
    v_cvt_pk_bf16_f32 v172, v68, v69
    v_cvt_pk_bf16_f32 v173, v70, v71
    v_pk_max_i16 v172, v172, 0
    v_pk_max_i16 v173, v173, 0
    v_pk_fma_f32 v[76:77], v[16:17], v[140:141], v[76:77]
    v_pk_fma_f32 v[78:79], v[16:17], v[142:143], v[78:79]
    v_pk_mul_f32 v[76:77], v[76:77], v[20:21]
    v_pk_mul_f32 v[78:79], v[78:79], v[20:21]
    v_cvt_pk_bf16_f32 v174, v76, v77
    v_cvt_pk_bf16_f32 v175, v78, v79
    v_pk_max_i16 v174, v174, 0
    v_pk_max_i16 v175, v175, 0
    buffer_store_dwordx4 v[172:175], v8, s[64:67], 0 offen offset:2048 sc1
    v_pk_fma_f32 v[72:73], v[18:19], v[124:125], v[72:73]
    v_pk_fma_f32 v[74:75], v[18:19], v[126:127], v[74:75]
    v_pk_mul_f32 v[72:73], v[72:73], v[22:23]
    v_pk_mul_f32 v[74:75], v[74:75], v[22:23]
    v_cvt_pk_bf16_f32 v176, v72, v73
    v_cvt_pk_bf16_f32 v177, v74, v75
    v_pk_max_i16 v176, v176, 0
    v_pk_max_i16 v177, v177, 0
    v_pk_fma_f32 v[80:81], v[18:19], v[140:141], v[80:81]
    v_pk_fma_f32 v[82:83], v[18:19], v[142:143], v[82:83]
    v_pk_mul_f32 v[80:81], v[80:81], v[22:23]
    v_pk_mul_f32 v[82:83], v[82:83], v[22:23]
    v_cvt_pk_bf16_f32 v178, v80, v81
    v_cvt_pk_bf16_f32 v179, v82, v83
    v_pk_max_i16 v178, v178, 0
    v_pk_max_i16 v179, v179, 0
    buffer_store_dwordx4 v[176:179], v8, s[64:67], s90 offen offset:2048 sc1
    v_pk_fma_f32 v[84:85], v[16:17], v[156:157], v[84:85]
    v_pk_fma_f32 v[86:87], v[16:17], v[158:159], v[86:87]
    v_pk_mul_f32 v[84:85], v[84:85], v[20:21]
    v_pk_mul_f32 v[86:87], v[86:87], v[20:21]
    v_cvt_pk_bf16_f32 v180, v84, v85
    v_cvt_pk_bf16_f32 v181, v86, v87
    v_pk_max_i16 v180, v180, 0
    v_pk_max_i16 v181, v181, 0
    buffer_store_dwordx2 v[180:181], v9, s[64:67], 0 offen sc1
    v_pk_fma_f32 v[88:89], v[18:19], v[156:157], v[88:89]
    v_pk_fma_f32 v[90:91], v[18:19], v[158:159], v[90:91]
    v_pk_mul_f32 v[88:89], v[88:89], v[22:23]
    v_pk_mul_f32 v[90:91], v[90:91], v[22:23]
    v_cvt_pk_bf16_f32 v184, v88, v89
    v_cvt_pk_bf16_f32 v185, v90, v91
    v_pk_max_i16 v184, v184, 0
    v_pk_max_i16 v185, v185, 0
    buffer_store_dwordx2 v[184:185], v9, s[64:67], s90 offen sc1
    s_xor_b32 s76, s3, 0
    s_lshl_b32 s77, s8, 2
    s_add_u32 s76, s76, s77
    s_mul_i32 s76, s76, 57344
    s_mul_i32 s77, s3, 14336
    s_add_u32 s76, s76, s77
    v_add_u32 v8, s76, v3
    s_xor_b32 s76, s3, 1
    s_lshl_b32 s77, s8, 2
    s_add_u32 s76, s76, s77
    s_mul_i32 s76, s76, 57344
    s_mul_i32 s77, s3, 14336
    s_add_u32 s76, s76, s77
    v_add_u32 v9, s76, v3
    s_xor_b32 s76, s3, 2
    s_lshl_b32 s77, s8, 2
    s_add_u32 s76, s76, s77
    s_mul_i32 s76, s76, 57344
    s_mul_i32 s77, s3, 14336
    s_add_u32 s76, s76, s77
    v_add_u32 v10, s76, v3
    s_xor_b32 s76, s3, 3
    s_lshl_b32 s77, s8, 2
    s_add_u32 s76, s76, s77
    s_mul_i32 s76, s76, 57344
    s_mul_i32 s77, s3, 14336
    s_add_u32 s76, s76, s77
    v_add_u32 v11, s76, v3
    v_lshrrev_b32 v4, 2, v0
    v_bfe_u32 v5, v0, 3, 2
    v_and_b32 v6, 3, v0
    v_lshl_add_u32 v4, v4, 7, s89
    v_lshl_add_u32 v4, v6, 3, v4
    v_xor_b32 v6, 0, v5
    v_lshl_add_u32 v32, v6, 5, v4
    v_xor_b32 v6, 1, v5
    v_lshl_add_u32 v33, v6, 5, v4
    v_xor_b32 v6, 2, v5
    v_lshl_add_u32 v34, v6, 5, v4
    v_xor_b32 v6, 3, v5
    v_lshl_add_u32 v35, v6, 5, v4
    s_lshl_b32 s76, s8, 2
    s_add_u32 s76, s76, s3
    s_lshl_b32 s76, s76, 14
    v_lshl_add_u32 v16, v2, 4, s76
    s_cmp_ge_u32 s9, 4
    s_cbranch_scc1 L_res_mirror
    s_lshl_b32 s76, s9, 12
    v_lshl_add_u32 v17, v1, 8, v16
    v_add_u32 v17, s76, v17
    v_mov_b32 v18, 2147418112
    v_mov_b32 v19, 2147418112
    s_branch L_res_done
L_res_mirror:
    s_lshl_b32 s76, s9, 2
    s_sub_u32 s76, 28, s76
    s_lshl_b32 s76, s76, 10
    s_add_u32 s76, s76, 8
    v_sub_u32 v18, 3, v1
    v_lshl_add_u32 v17, v18, 8, v16
    v_add_u32 v17, s76, v17
    v_add_u32 v18, 256, v17
    v_add_u32 v19, 3328, v17
    v_add_u32 v22, 8, v16
    v_or_b32 v23, s9, v3
    v_and_b32 v23, 0x307, v23
    v_cmp_eq_u32 vcc, 4, v23
    s_nop 1
    v_cndmask_b32 v19, v19, v22, vcc
L_res_done:
    buffer_load_dwordx2 v[36:37], v17, s[60:63], 0 offen offset:0 sc1
    buffer_load_dwordx2 v[38:39], v17, s[60:63], 0 offen offset:1024 sc1
    buffer_load_dwordx2 v[40:41], v17, s[60:63], 0 offen offset:2048 sc1
    buffer_load_dwordx2 v[42:43], v17, s[60:63], 0 offen offset:3072 sc1
    buffer_load_ushort v44, v18, s[60:63], 0 offen offset:0 sc1
    buffer_load_ushort v45, v18, s[60:63], 0 offen offset:1024 sc1
    buffer_load_ushort v46, v18, s[60:63], 0 offen offset:2048 sc1
    buffer_load_ushort v47, v19, s[60:63], 0 offen sc1
    s_lshl_b32 s76, s11, 6
    s_add_u32 s76, s76, s10
    s_and_b32 s77, s3, 1
    s_lshl_b32 s77, s77, 5
    s_add_u32 s76, s76, s77
    v_lshl_add_u32 v20, v2, 1, s76
    v_cmp_eq_u32 vcc, 0, v20
    v_sub_u32 v21, 0x800, v20
    v_mov_b32 v22, 0x400
    s_cmp_ge_u32 s3, 2
    s_cselect_b64 s[94:95], -1, 0
    v_cndmask_b32 v21, v21, v22, vcc
    v_cndmask_b32 v20, v20, v21, s[94:95]
    s_lshl_b32 s76, s9, 7
    v_lshl_add_u32 v21, v1, 5, s76
    v_lshl_add_u32 v20, v20, 10, v21
    s_waitcnt vmcnt(0)
    s_cmp_ge_u32 s9, 4
    s_cbranch_scc1 L_unp_mirror
    v_lshlrev_b32 v48, 16, v36
    v_and_b32 v49, s84, v36
    v_lshlrev_b32 v50, 16, v37
    v_and_b32 v51, s84, v37
    v_lshlrev_b32 v64, 16, v38
    v_and_b32 v65, s84, v38
    v_lshlrev_b32 v66, 16, v39
    v_and_b32 v67, s84, v39
    v_lshlrev_b32 v80, 16, v40
    v_and_b32 v81, s84, v40
    v_lshlrev_b32 v82, 16, v41
    v_and_b32 v83, s84, v41
    v_lshlrev_b32 v96, 16, v42
    v_and_b32 v97, s84, v42
    v_lshlrev_b32 v98, 16, v43
    v_and_b32 v99, s84, v43
    s_branch L_unp_done
L_unp_mirror:
    v_lshlrev_b32 v48, 16, v47
    v_and_b32 v49, s84, v43
    v_lshlrev_b32 v50, 16, v43
    v_and_b32 v51, s84, v42
    v_lshlrev_b32 v64, 16, v46
    v_and_b32 v65, s84, v41
    v_lshlrev_b32 v66, 16, v41
    v_and_b32 v67, s84, v40
    v_lshlrev_b32 v80, 16, v45
    v_and_b32 v81, s84, v39
    v_lshlrev_b32 v82, 16, v39
    v_and_b32 v83, s84, v38
    v_lshlrev_b32 v96, 16, v44
    v_and_b32 v97, s84, v37
    v_lshlrev_b32 v98, 16, v37
    v_and_b32 v99, s84, v36
L_unp_done:
    s_mov_b64 exec, 1
    ds_add_rtn_u32 v4, v14, v15 offset:112
    s_mov_b64 exec, -1
    s_waitcnt lgkmcnt(0)
    v_readfirstlane_b32 s76, v4
    s_nop 3
    s_cmp_lg_u32 s76, 3
    s_cbranch_scc1 L_ar4_skip
    s_mov_b64 exec, 1
    buffer_atomic_add v15, v31, s[52:55], 0 offen sc1
    s_mov_b64 exec, -1
L_ar4_skip:
    s_mov_b32 s79, 0
L_wd1_l:
    ds_read_b32 v4, v29 offset:64
    s_add_u32 s79, s79, 1
    s_waitcnt lgkmcnt(0)
    v_readfirstlane_b32 s78, v4
    s_cmp_ge_u32 s79, 0x200000
    s_cbranch_scc1 L_wd1_x
    s_cmp_lt_u32 s78, 1
    s_cbranch_scc1 L_wd1_l
L_wd1_x:
    s_mov_b32 s79, 0
L_wg3_l:
    ds_read_b32 v4, v14 offset:40
    s_add_u32 s79, s79, 1
    s_waitcnt lgkmcnt(0)
    v_readfirstlane_b32 s78, v4
    s_cmp_ge_u32 s79, 0x200000
    s_cbranch_scc1 L_wg3_x
    s_cmp_lt_u32 s78, 1
    s_cbranch_scc1 L_wg3_l
L_wg3_x:
    s_add_u32 s100, 0, s99
    s_lshl_b32 s100, s100, 10
    buffer_load_dwordx4 v[144:147], v8, s[64:67], s100 offen sc1
    buffer_load_dwordx4 v[148:151], v9, s[64:67], s100 offen sc1
    buffer_load_dwordx4 v[152:155], v10, s[64:67], s100 offen sc1
    buffer_load_dwordx4 v[156:159], v11, s[64:67], s100 offen sc1
    s_add_u32 s100, 1, s99
    s_lshl_b32 s100, s100, 10
    buffer_load_dwordx4 v[160:163], v8, s[64:67], s100 offen sc1
    buffer_load_dwordx4 v[164:167], v9, s[64:67], s100 offen sc1
    buffer_load_dwordx4 v[168:171], v10, s[64:67], s100 offen sc1
    buffer_load_dwordx4 v[172:175], v11, s[64:67], s100 offen sc1
    s_add_u32 s100, 4, s99
    s_lshl_b32 s100, s100, 10
    buffer_load_dwordx4 v[176:179], v8, s[64:67], s100 offen sc1
    buffer_load_dwordx4 v[180:183], v9, s[64:67], s100 offen sc1
    buffer_load_dwordx4 v[184:187], v10, s[64:67], s100 offen sc1
    buffer_load_dwordx4 v[188:191], v11, s[64:67], s100 offen sc1
    ds_read_b64_tr_b16 v[112:113], v32 offset:0
    ds_read_b64_tr_b16 v[114:115], v32 offset:2048
    ds_read_b64_tr_b16 v[116:117], v33 offset:0
    ds_read_b64_tr_b16 v[118:119], v33 offset:2048
    ds_read_b64_tr_b16 v[120:121], v34 offset:0
    ds_read_b64_tr_b16 v[122:123], v34 offset:2048
    ds_read_b64_tr_b16 v[124:125], v35 offset:0
    ds_read_b64_tr_b16 v[126:127], v35 offset:2048
    s_waitcnt vmcnt(8)
    ds_read_b64_tr_b16 v[128:129], v32 offset:4096
    ds_read_b64_tr_b16 v[130:131], v32 offset:6144
    s_waitcnt lgkmcnt(8)
    v_mfma_f32_16x16x32_bf16 v[52:55], v[112:115], v[148:151], 0
    v_mfma_f32_16x16x32_bf16 v[56:59], v[112:115], v[152:155], 0
    v_mfma_f32_16x16x32_bf16 v[60:63], v[112:115], v[156:159], 0
    v_mfma_f32_16x16x32_bf16 v[48:51], v[112:115], v[144:147], v[48:51]
    s_add_u32 s100, 5, s99
    s_lshl_b32 s100, s100, 10
    buffer_load_dwordx4 v[192:195], v8, s[64:67], s100 offen sc1
    ds_read_b64_tr_b16 v[132:133], v33 offset:4096
    ds_read_b64_tr_b16 v[134:135], v33 offset:6144
    s_waitcnt lgkmcnt(8)
    v_mfma_f32_16x16x32_bf16 v[68:71], v[116:119], v[148:151], 0
    v_mfma_f32_16x16x32_bf16 v[72:75], v[116:119], v[152:155], 0
    v_mfma_f32_16x16x32_bf16 v[76:79], v[116:119], v[156:159], 0
    v_mfma_f32_16x16x32_bf16 v[64:67], v[116:119], v[144:147], v[64:67]
    buffer_load_dwordx4 v[196:199], v9, s[64:67], s100 offen sc1
    ds_read_b64_tr_b16 v[136:137], v34 offset:4096
    ds_read_b64_tr_b16 v[138:139], v34 offset:6144
    s_waitcnt lgkmcnt(8)
    v_mfma_f32_16x16x32_bf16 v[84:87], v[120:123], v[148:151], 0
    v_mfma_f32_16x16x32_bf16 v[88:91], v[120:123], v[152:155], 0
    v_mfma_f32_16x16x32_bf16 v[92:95], v[120:123], v[156:159], 0
    v_mfma_f32_16x16x32_bf16 v[80:83], v[120:123], v[144:147], v[80:83]
    buffer_load_dwordx4 v[200:203], v10, s[64:67], s100 offen sc1
    ds_read_b64_tr_b16 v[140:141], v35 offset:4096
    ds_read_b64_tr_b16 v[142:143], v35 offset:6144
    s_waitcnt lgkmcnt(8)
    v_mfma_f32_16x16x32_bf16 v[100:103], v[124:127], v[148:151], 0
    v_mfma_f32_16x16x32_bf16 v[104:107], v[124:127], v[152:155], 0
    v_mfma_f32_16x16x32_bf16 v[108:111], v[124:127], v[156:159], 0
    v_mfma_f32_16x16x32_bf16 v[96:99], v[124:127], v[144:147], v[96:99]
    buffer_load_dwordx4 v[204:207], v11, s[64:67], s100 offen sc1
    s_waitcnt vmcnt(8)
    ds_read_b64_tr_b16 v[112:113], v32 offset:8192
    ds_read_b64_tr_b16 v[114:115], v32 offset:10240
    s_waitcnt lgkmcnt(8)
    v_mfma_f32_16x16x32_bf16 v[52:55], v[128:131], v[164:167], v[52:55]
    v_mfma_f32_16x16x32_bf16 v[56:59], v[128:131], v[168:171], v[56:59]
    v_mfma_f32_16x16x32_bf16 v[60:63], v[128:131], v[172:175], v[60:63]
    v_mfma_f32_16x16x32_bf16 v[48:51], v[128:131], v[160:163], v[48:51]
    s_sub_u32 s100, 7, s99
    s_lshl_b32 s100, s100, 10
    buffer_load_dwordx4 v[208:211], v8, s[64:67], s100 offen sc1
    ds_read_b64_tr_b16 v[116:117], v33 offset:8192
    ds_read_b64_tr_b16 v[118:119], v33 offset:10240
    s_waitcnt lgkmcnt(8)
    v_mfma_f32_16x16x32_bf16 v[68:71], v[132:135], v[164:167], v[68:71]
    v_mfma_f32_16x16x32_bf16 v[72:75], v[132:135], v[168:171], v[72:75]
    v_mfma_f32_16x16x32_bf16 v[76:79], v[132:135], v[172:175], v[76:79]
    v_mfma_f32_16x16x32_bf16 v[64:67], v[132:135], v[160:163], v[64:67]
    buffer_load_dwordx4 v[212:215], v9, s[64:67], s100 offen sc1
    ds_read_b64_tr_b16 v[120:121], v34 offset:8192
    ds_read_b64_tr_b16 v[122:123], v34 offset:10240
    s_waitcnt lgkmcnt(8)
    v_mfma_f32_16x16x32_bf16 v[84:87], v[136:139], v[164:167], v[84:87]
    v_mfma_f32_16x16x32_bf16 v[88:91], v[136:139], v[168:171], v[88:91]
    v_mfma_f32_16x16x32_bf16 v[92:95], v[136:139], v[172:175], v[92:95]
    v_mfma_f32_16x16x32_bf16 v[80:83], v[136:139], v[160:163], v[80:83]
    buffer_load_dwordx4 v[216:219], v10, s[64:67], s100 offen sc1
    ds_read_b64_tr_b16 v[124:125], v35 offset:8192
    ds_read_b64_tr_b16 v[126:127], v35 offset:10240
    s_waitcnt lgkmcnt(8)
    v_mfma_f32_16x16x32_bf16 v[100:103], v[140:143], v[164:167], v[100:103]
    v_mfma_f32_16x16x32_bf16 v[104:107], v[140:143], v[168:171], v[104:107]
    v_mfma_f32_16x16x32_bf16 v[108:111], v[140:143], v[172:175], v[108:111]
    v_mfma_f32_16x16x32_bf16 v[96:99], v[140:143], v[160:163], v[96:99]
    buffer_load_dwordx4 v[220:223], v11, s[64:67], s100 offen sc1
    s_waitcnt vmcnt(8)
    ds_read_b64_tr_b16 v[128:129], v32 offset:12288
    ds_read_b64_tr_b16 v[130:131], v32 offset:14336
    s_waitcnt lgkmcnt(8)
    v_mfma_f32_16x16x32_bf16 v[52:55], v[112:115], v[180:183], v[52:55]
    v_mfma_f32_16x16x32_bf16 v[56:59], v[112:115], v[184:187], v[56:59]
    v_mfma_f32_16x16x32_bf16 v[60:63], v[112:115], v[188:191], v[60:63]
    v_mfma_f32_16x16x32_bf16 v[48:51], v[112:115], v[176:179], v[48:51]
    s_sub_u32 s100, 8, s99
    s_lshl_b32 s100, s100, 10
    buffer_load_dwordx4 v[224:227], v8, s[64:67], s100 offen sc1
    ds_read_b64_tr_b16 v[132:133], v33 offset:12288
    ds_read_b64_tr_b16 v[134:135], v33 offset:14336
    s_waitcnt lgkmcnt(8)
    v_mfma_f32_16x16x32_bf16 v[68:71], v[116:119], v[180:183], v[68:71]
    v_mfma_f32_16x16x32_bf16 v[72:75], v[116:119], v[184:187], v[72:75]
    v_mfma_f32_16x16x32_bf16 v[76:79], v[116:119], v[188:191], v[76:79]
    v_mfma_f32_16x16x32_bf16 v[64:67], v[116:119], v[176:179], v[64:67]
    buffer_load_dwordx4 v[228:231], v9, s[64:67], s100 offen sc1
    ds_read_b64_tr_b16 v[136:137], v34 offset:12288
    ds_read_b64_tr_b16 v[138:139], v34 offset:14336
    s_waitcnt lgkmcnt(8)
    v_mfma_f32_16x16x32_bf16 v[84:87], v[120:123], v[180:183], v[84:87]
    v_mfma_f32_16x16x32_bf16 v[88:91], v[120:123], v[184:187], v[88:91]
    v_mfma_f32_16x16x32_bf16 v[92:95], v[120:123], v[188:191], v[92:95]
    v_mfma_f32_16x16x32_bf16 v[80:83], v[120:123], v[176:179], v[80:83]
    buffer_load_dwordx4 v[232:235], v10, s[64:67], s100 offen sc1
    ds_read_b64_tr_b16 v[140:141], v35 offset:12288
    ds_read_b64_tr_b16 v[142:143], v35 offset:14336
    s_waitcnt lgkmcnt(8)
    v_mfma_f32_16x16x32_bf16 v[100:103], v[124:127], v[180:183], v[100:103]
    v_mfma_f32_16x16x32_bf16 v[104:107], v[124:127], v[184:187], v[104:107]
    v_mfma_f32_16x16x32_bf16 v[108:111], v[124:127], v[188:191], v[108:111]
    v_mfma_f32_16x16x32_bf16 v[96:99], v[124:127], v[176:179], v[96:99]
    buffer_load_dwordx4 v[236:239], v11, s[64:67], s100 offen sc1
    s_waitcnt vmcnt(8)
    ds_read_b64_tr_b16 v[112:113], v32 offset:16384
    ds_read_b64_tr_b16 v[114:115], v32 offset:18432
    s_waitcnt lgkmcnt(8)
    v_mfma_f32_16x16x32_bf16 v[52:55], v[128:131], v[196:199], v[52:55]
    v_mfma_f32_16x16x32_bf16 v[56:59], v[128:131], v[200:203], v[56:59]
    v_mfma_f32_16x16x32_bf16 v[60:63], v[128:131], v[204:207], v[60:63]
    v_mfma_f32_16x16x32_bf16 v[48:51], v[128:131], v[192:195], v[48:51]
    buffer_load_dword v25, v31, s[52:55], 0 offen sc1
    s_sub_u32 s100, 11, s99
    s_lshl_b32 s100, s100, 10
    buffer_load_dwordx4 v[240:243], v8, s[64:67], s100 offen sc1
    ds_read_b64_tr_b16 v[116:117], v33 offset:16384
    ds_read_b64_tr_b16 v[118:119], v33 offset:18432
    s_waitcnt lgkmcnt(8)
    v_mfma_f32_16x16x32_bf16 v[68:71], v[132:135], v[196:199], v[68:71]
    v_mfma_f32_16x16x32_bf16 v[72:75], v[132:135], v[200:203], v[72:75]
    v_mfma_f32_16x16x32_bf16 v[76:79], v[132:135], v[204:207], v[76:79]
    v_mfma_f32_16x16x32_bf16 v[64:67], v[132:135], v[192:195], v[64:67]
    buffer_load_dwordx4 v[244:247], v9, s[64:67], s100 offen sc1
    ds_read_b64_tr_b16 v[120:121], v34 offset:16384
    ds_read_b64_tr_b16 v[122:123], v34 offset:18432
    s_waitcnt lgkmcnt(8)
    v_mfma_f32_16x16x32_bf16 v[84:87], v[136:139], v[196:199], v[84:87]
    v_mfma_f32_16x16x32_bf16 v[88:91], v[136:139], v[200:203], v[88:91]
    v_mfma_f32_16x16x32_bf16 v[92:95], v[136:139], v[204:207], v[92:95]
    v_mfma_f32_16x16x32_bf16 v[80:83], v[136:139], v[192:195], v[80:83]
    buffer_load_dwordx4 v[248:251], v10, s[64:67], s100 offen sc1
    ds_read_b64_tr_b16 v[124:125], v35 offset:16384
    ds_read_b64_tr_b16 v[126:127], v35 offset:18432
    s_waitcnt lgkmcnt(8)
    v_mfma_f32_16x16x32_bf16 v[100:103], v[140:143], v[196:199], v[100:103]
    v_mfma_f32_16x16x32_bf16 v[104:107], v[140:143], v[200:203], v[104:107]
    v_mfma_f32_16x16x32_bf16 v[108:111], v[140:143], v[204:207], v[108:111]
    v_mfma_f32_16x16x32_bf16 v[96:99], v[140:143], v[192:195], v[96:99]
    buffer_load_dwordx4 v[252:255], v11, s[64:67], s100 offen sc1
    s_waitcnt vmcnt(9)
    ds_read_b64_tr_b16 v[128:129], v32 offset:20480
    ds_read_b64_tr_b16 v[130:131], v32 offset:22528
    s_waitcnt lgkmcnt(8)
    v_mfma_f32_16x16x32_bf16 v[52:55], v[112:115], v[212:215], v[52:55]
    v_mfma_f32_16x16x32_bf16 v[56:59], v[112:115], v[216:219], v[56:59]
    v_mfma_f32_16x16x32_bf16 v[60:63], v[112:115], v[220:223], v[60:63]
    v_mfma_f32_16x16x32_bf16 v[48:51], v[112:115], v[208:211], v[48:51]
    s_sub_u32 s100, 12, s99
    s_lshl_b32 s100, s100, 10
    buffer_load_dwordx4 v[144:147], v8, s[64:67], s100 offen sc1
    ds_read_b64_tr_b16 v[132:133], v33 offset:20480
    ds_read_b64_tr_b16 v[134:135], v33 offset:22528
    s_waitcnt lgkmcnt(8)
    v_mfma_f32_16x16x32_bf16 v[68:71], v[116:119], v[212:215], v[68:71]
    v_mfma_f32_16x16x32_bf16 v[72:75], v[116:119], v[216:219], v[72:75]
    v_mfma_f32_16x16x32_bf16 v[76:79], v[116:119], v[220:223], v[76:79]
    v_mfma_f32_16x16x32_bf16 v[64:67], v[116:119], v[208:211], v[64:67]
    buffer_load_dwordx4 v[148:151], v9, s[64:67], s100 offen sc1
    ds_read_b64_tr_b16 v[136:137], v34 offset:20480
    ds_read_b64_tr_b16 v[138:139], v34 offset:22528
    s_waitcnt lgkmcnt(8)
    v_mfma_f32_16x16x32_bf16 v[84:87], v[120:123], v[212:215], v[84:87]
    v_mfma_f32_16x16x32_bf16 v[88:91], v[120:123], v[216:219], v[88:91]
    v_mfma_f32_16x16x32_bf16 v[92:95], v[120:123], v[220:223], v[92:95]
    v_mfma_f32_16x16x32_bf16 v[80:83], v[120:123], v[208:211], v[80:83]
    buffer_load_dwordx4 v[152:155], v10, s[64:67], s100 offen sc1
    ds_read_b64_tr_b16 v[140:141], v35 offset:20480
    ds_read_b64_tr_b16 v[142:143], v35 offset:22528
    s_waitcnt lgkmcnt(8)
    v_mfma_f32_16x16x32_bf16 v[100:103], v[124:127], v[212:215], v[100:103]
    v_mfma_f32_16x16x32_bf16 v[104:107], v[124:127], v[216:219], v[104:107]
    v_mfma_f32_16x16x32_bf16 v[108:111], v[124:127], v[220:223], v[108:111]
    v_mfma_f32_16x16x32_bf16 v[96:99], v[124:127], v[208:211], v[96:99]
    buffer_load_dwordx4 v[156:159], v11, s[64:67], s100 offen sc1
    s_mov_b64 exec, 1
    ds_add_u32 v29, v15 offset:80
    s_mov_b64 exec, -1
    s_waitcnt vmcnt(9)
    ds_read_b64_tr_b16 v[112:113], v32 offset:24576
    ds_read_b64_tr_b16 v[114:115], v32 offset:26624
    s_waitcnt lgkmcnt(9)
    v_mfma_f32_16x16x32_bf16 v[52:55], v[128:131], v[228:231], v[52:55]
    v_mfma_f32_16x16x32_bf16 v[56:59], v[128:131], v[232:235], v[56:59]
    v_mfma_f32_16x16x32_bf16 v[60:63], v[128:131], v[236:239], v[60:63]
    v_mfma_f32_16x16x32_bf16 v[48:51], v[128:131], v[224:227], v[48:51]
    s_waitcnt vmcnt(8)
    v_cmp_gt_u32 vcc, 16, v25
    s_mov_b32 s76, 0
    s_cbranch_vccz L_p4_ok
L_p4_loop:
    buffer_load_dword v25, v31, s[52:55], 0 offen sc1
    s_add_u32 s76, s76, 1
    s_cmp_ge_u32 s76, 0x40000
    s_cbranch_scc1 L_p4_ok
    s_waitcnt vmcnt(0)
    v_cmp_gt_u32 vcc, 16, v25
    s_cbranch_vccnz L_p4_loop
L_p4_ok:
    s_add_u32 s100, 2, s99
    s_lshl_b32 s100, s100, 10
    buffer_load_dwordx4 v[160:163], v8, s[64:67], s100 offen sc1
    ds_read_b64_tr_b16 v[116:117], v33 offset:24576
    ds_read_b64_tr_b16 v[118:119], v33 offset:26624
    s_waitcnt lgkmcnt(9)
    v_mfma_f32_16x16x32_bf16 v[68:71], v[132:135], v[228:231], v[68:71]
    v_mfma_f32_16x16x32_bf16 v[72:75], v[132:135], v[232:235], v[72:75]
    v_mfma_f32_16x16x32_bf16 v[76:79], v[132:135], v[236:239], v[76:79]
    v_mfma_f32_16x16x32_bf16 v[64:67], v[132:135], v[224:227], v[64:67]
    buffer_load_dwordx4 v[164:167], v9, s[64:67], s100 offen sc1
    ds_read_b64_tr_b16 v[120:121], v34 offset:24576
    ds_read_b64_tr_b16 v[122:123], v34 offset:26624
    s_waitcnt lgkmcnt(9)
    v_mfma_f32_16x16x32_bf16 v[84:87], v[136:139], v[228:231], v[84:87]
    v_mfma_f32_16x16x32_bf16 v[88:91], v[136:139], v[232:235], v[88:91]
    v_mfma_f32_16x16x32_bf16 v[92:95], v[136:139], v[236:239], v[92:95]
    v_mfma_f32_16x16x32_bf16 v[80:83], v[136:139], v[224:227], v[80:83]
    buffer_load_dwordx4 v[168:171], v10, s[64:67], s100 offen sc1
    ds_read_b64_tr_b16 v[124:125], v35 offset:24576
    ds_read_b64_tr_b16 v[126:127], v35 offset:26624
    s_waitcnt lgkmcnt(9)
    v_mfma_f32_16x16x32_bf16 v[100:103], v[140:143], v[228:231], v[100:103]
    v_mfma_f32_16x16x32_bf16 v[104:107], v[140:143], v[232:235], v[104:107]
    v_mfma_f32_16x16x32_bf16 v[108:111], v[140:143], v[236:239], v[108:111]
    v_mfma_f32_16x16x32_bf16 v[96:99], v[140:143], v[224:227], v[96:99]
    buffer_load_dwordx4 v[172:175], v11, s[64:67], s100 offen sc1
    s_waitcnt vmcnt(8)
    ds_read_b64_tr_b16 v[128:129], v32 offset:28672
    ds_read_b64_tr_b16 v[130:131], v32 offset:30720
    s_waitcnt lgkmcnt(8)
    v_mfma_f32_16x16x32_bf16 v[52:55], v[112:115], v[244:247], v[52:55]
    v_mfma_f32_16x16x32_bf16 v[56:59], v[112:115], v[248:251], v[56:59]
    v_mfma_f32_16x16x32_bf16 v[60:63], v[112:115], v[252:255], v[60:63]
    v_mfma_f32_16x16x32_bf16 v[48:51], v[112:115], v[240:243], v[48:51]
    s_add_u32 s100, 3, s99
    s_lshl_b32 s100, s100, 10
    buffer_load_dwordx4 v[176:179], v8, s[64:67], s100 offen sc1
    ds_read_b64_tr_b16 v[132:133], v33 offset:28672
    ds_read_b64_tr_b16 v[134:135], v33 offset:30720
    s_waitcnt lgkmcnt(8)
    v_mfma_f32_16x16x32_bf16 v[68:71], v[116:119], v[244:247], v[68:71]
    v_mfma_f32_16x16x32_bf16 v[72:75], v[116:119], v[248:251], v[72:75]
    v_mfma_f32_16x16x32_bf16 v[76:79], v[116:119], v[252:255], v[76:79]
    v_mfma_f32_16x16x32_bf16 v[64:67], v[116:119], v[240:243], v[64:67]
    buffer_load_dwordx4 v[180:183], v9, s[64:67], s100 offen sc1
    ds_read_b64_tr_b16 v[136:137], v34 offset:28672
    ds_read_b64_tr_b16 v[138:139], v34 offset:30720
    s_waitcnt lgkmcnt(8)
    v_mfma_f32_16x16x32_bf16 v[84:87], v[120:123], v[244:247], v[84:87]
    v_mfma_f32_16x16x32_bf16 v[88:91], v[120:123], v[248:251], v[88:91]
    v_mfma_f32_16x16x32_bf16 v[92:95], v[120:123], v[252:255], v[92:95]
    v_mfma_f32_16x16x32_bf16 v[80:83], v[120:123], v[240:243], v[80:83]
    buffer_load_dwordx4 v[184:187], v10, s[64:67], s100 offen sc1
    ds_read_b64_tr_b16 v[140:141], v35 offset:28672
    ds_read_b64_tr_b16 v[142:143], v35 offset:30720
    s_waitcnt lgkmcnt(8)
    v_mfma_f32_16x16x32_bf16 v[100:103], v[124:127], v[244:247], v[100:103]
    v_mfma_f32_16x16x32_bf16 v[104:107], v[124:127], v[248:251], v[104:107]
    v_mfma_f32_16x16x32_bf16 v[108:111], v[124:127], v[252:255], v[108:111]
    v_mfma_f32_16x16x32_bf16 v[96:99], v[124:127], v[240:243], v[96:99]
    buffer_load_dwordx4 v[188:191], v11, s[64:67], s100 offen sc1
    s_waitcnt vmcnt(8)
    ds_read_b64_tr_b16 v[112:113], v32 offset:32768
    ds_read_b64_tr_b16 v[114:115], v32 offset:34816
    s_waitcnt lgkmcnt(8)
    v_mfma_f32_16x16x32_bf16 v[52:55], v[128:131], v[148:151], v[52:55]
    v_mfma_f32_16x16x32_bf16 v[56:59], v[128:131], v[152:155], v[56:59]
    v_mfma_f32_16x16x32_bf16 v[60:63], v[128:131], v[156:159], v[60:63]
    v_mfma_f32_16x16x32_bf16 v[48:51], v[128:131], v[144:147], v[48:51]
    s_add_u32 s100, 6, s99
    s_lshl_b32 s100, s100, 10
    buffer_load_dwordx4 v[192:195], v8, s[64:67], s100 offen sc1
    ds_read_b64_tr_b16 v[116:117], v33 offset:32768
    ds_read_b64_tr_b16 v[118:119], v33 offset:34816
    s_waitcnt lgkmcnt(8)
    v_mfma_f32_16x16x32_bf16 v[68:71], v[132:135], v[148:151], v[68:71]
    v_mfma_f32_16x16x32_bf16 v[72:75], v[132:135], v[152:155], v[72:75]
    v_mfma_f32_16x16x32_bf16 v[76:79], v[132:135], v[156:159], v[76:79]
    v_mfma_f32_16x16x32_bf16 v[64:67], v[132:135], v[144:147], v[64:67]
    buffer_load_dwordx4 v[196:199], v9, s[64:67], s100 offen sc1
    ds_read_b64_tr_b16 v[120:121], v34 offset:32768
    ds_read_b64_tr_b16 v[122:123], v34 offset:34816
    s_waitcnt lgkmcnt(8)
    v_mfma_f32_16x16x32_bf16 v[84:87], v[136:139], v[148:151], v[84:87]
    v_mfma_f32_16x16x32_bf16 v[88:91], v[136:139], v[152:155], v[88:91]
    v_mfma_f32_16x16x32_bf16 v[92:95], v[136:139], v[156:159], v[92:95]
    v_mfma_f32_16x16x32_bf16 v[80:83], v[136:139], v[144:147], v[80:83]
    buffer_load_dwordx4 v[200:203], v10, s[64:67], s100 offen sc1
    ds_read_b64_tr_b16 v[124:125], v35 offset:32768
    ds_read_b64_tr_b16 v[126:127], v35 offset:34816
    s_waitcnt lgkmcnt(8)
    v_mfma_f32_16x16x32_bf16 v[100:103], v[140:143], v[148:151], v[100:103]
    v_mfma_f32_16x16x32_bf16 v[104:107], v[140:143], v[152:155], v[104:107]
    v_mfma_f32_16x16x32_bf16 v[108:111], v[140:143], v[156:159], v[108:111]
    v_mfma_f32_16x16x32_bf16 v[96:99], v[140:143], v[144:147], v[96:99]
    buffer_load_dwordx4 v[204:207], v11, s[64:67], s100 offen sc1
    s_mov_b32 s79, 0
L_wd2_l:
    ds_read_b32 v4, v29 offset:96
    s_add_u32 s79, s79, 1
    s_waitcnt lgkmcnt(0)
    v_readfirstlane_b32 s78, v4
    s_cmp_ge_u32 s79, 0x200000
    s_cbranch_scc1 L_wd2_x
    s_cmp_lt_u32 s78, 1
    s_cbranch_scc1 L_wd2_l
L_wd2_x:
    s_waitcnt vmcnt(8)
    ds_read_b64_tr_b16 v[128:129], v32 offset:0
    ds_read_b64_tr_b16 v[130:131], v32 offset:2048
    s_waitcnt lgkmcnt(8)
    v_mfma_f32_16x16x32_bf16 v[52:55], v[112:115], v[164:167], v[52:55]
    v_mfma_f32_16x16x32_bf16 v[56:59], v[112:115], v[168:171], v[56:59]
    v_mfma_f32_16x16x32_bf16 v[60:63], v[112:115], v[172:175], v[60:63]
    v_mfma_f32_16x16x32_bf16 v[48:51], v[112:115], v[160:163], v[48:51]
    s_sub_u32 s100, 9, s99
    s_lshl_b32 s100, s100, 10
    buffer_load_dwordx4 v[208:211], v8, s[64:67], s100 offen sc1
    ds_read_b64_tr_b16 v[132:133], v33 offset:0
    ds_read_b64_tr_b16 v[134:135], v33 offset:2048
    s_waitcnt lgkmcnt(8)
    v_mfma_f32_16x16x32_bf16 v[68:71], v[116:119], v[164:167], v[68:71]
    v_mfma_f32_16x16x32_bf16 v[72:75], v[116:119], v[168:171], v[72:75]
    v_mfma_f32_16x16x32_bf16 v[76:79], v[116:119], v[172:175], v[76:79]
    v_mfma_f32_16x16x32_bf16 v[64:67], v[116:119], v[160:163], v[64:67]
    buffer_load_dwordx4 v[212:215], v9, s[64:67], s100 offen sc1
    ds_read_b64_tr_b16 v[136:137], v34 offset:0
    ds_read_b64_tr_b16 v[138:139], v34 offset:2048
    s_waitcnt lgkmcnt(8)
    v_mfma_f32_16x16x32_bf16 v[84:87], v[120:123], v[164:167], v[84:87]
    v_mfma_f32_16x16x32_bf16 v[88:91], v[120:123], v[168:171], v[88:91]
    v_mfma_f32_16x16x32_bf16 v[92:95], v[120:123], v[172:175], v[92:95]
    v_mfma_f32_16x16x32_bf16 v[80:83], v[120:123], v[160:163], v[80:83]
    buffer_load_dwordx4 v[216:219], v10, s[64:67], s100 offen sc1
    ds_read_b64_tr_b16 v[140:141], v35 offset:0
    ds_read_b64_tr_b16 v[142:143], v35 offset:2048
    s_waitcnt lgkmcnt(8)
    v_mfma_f32_16x16x32_bf16 v[100:103], v[124:127], v[164:167], v[100:103]
    v_mfma_f32_16x16x32_bf16 v[104:107], v[124:127], v[168:171], v[104:107]
    v_mfma_f32_16x16x32_bf16 v[108:111], v[124:127], v[172:175], v[108:111]
    v_mfma_f32_16x16x32_bf16 v[96:99], v[124:127], v[160:163], v[96:99]
    buffer_load_dwordx4 v[220:223], v11, s[64:67], s100 offen sc1
    s_waitcnt vmcnt(8)
    ds_read_b64_tr_b16 v[112:113], v32 offset:4096
    ds_read_b64_tr_b16 v[114:115], v32 offset:6144
    s_waitcnt lgkmcnt(8)
    v_mfma_f32_16x16x32_bf16 v[52:55], v[128:131], v[180:183], v[52:55]
    v_mfma_f32_16x16x32_bf16 v[56:59], v[128:131], v[184:187], v[56:59]
    v_mfma_f32_16x16x32_bf16 v[60:63], v[128:131], v[188:191], v[60:63]
    v_mfma_f32_16x16x32_bf16 v[48:51], v[128:131], v[176:179], v[48:51]
    s_sub_u32 s100, 10, s99
    s_lshl_b32 s100, s100, 10
    buffer_load_dwordx4 v[224:227], v8, s[64:67], s100 offen sc1
    ds_read_b64_tr_b16 v[116:117], v33 offset:4096
    ds_read_b64_tr_b16 v[118:119], v33 offset:6144
    s_waitcnt lgkmcnt(8)
    v_mfma_f32_16x16x32_bf16 v[68:71], v[132:135], v[180:183], v[68:71]
    v_mfma_f32_16x16x32_bf16 v[72:75], v[132:135], v[184:187], v[72:75]
    v_mfma_f32_16x16x32_bf16 v[76:79], v[132:135], v[188:191], v[76:79]
    v_mfma_f32_16x16x32_bf16 v[64:67], v[132:135], v[176:179], v[64:67]
    buffer_load_dwordx4 v[228:231], v9, s[64:67], s100 offen sc1
    ds_read_b64_tr_b16 v[120:121], v34 offset:4096
    ds_read_b64_tr_b16 v[122:123], v34 offset:6144
    s_waitcnt lgkmcnt(8)
    v_mfma_f32_16x16x32_bf16 v[84:87], v[136:139], v[180:183], v[84:87]
    v_mfma_f32_16x16x32_bf16 v[88:91], v[136:139], v[184:187], v[88:91]
    v_mfma_f32_16x16x32_bf16 v[92:95], v[136:139], v[188:191], v[92:95]
    v_mfma_f32_16x16x32_bf16 v[80:83], v[136:139], v[176:179], v[80:83]
    buffer_load_dwordx4 v[232:235], v10, s[64:67], s100 offen sc1
    ds_read_b64_tr_b16 v[124:125], v35 offset:4096
    ds_read_b64_tr_b16 v[126:127], v35 offset:6144
    s_waitcnt lgkmcnt(8)
    v_mfma_f32_16x16x32_bf16 v[100:103], v[140:143], v[180:183], v[100:103]
    v_mfma_f32_16x16x32_bf16 v[104:107], v[140:143], v[184:187], v[104:107]
    v_mfma_f32_16x16x32_bf16 v[108:111], v[140:143], v[188:191], v[108:111]
    v_mfma_f32_16x16x32_bf16 v[96:99], v[140:143], v[176:179], v[96:99]
    buffer_load_dwordx4 v[236:239], v11, s[64:67], s100 offen sc1
    s_waitcnt vmcnt(8)
    ds_read_b64_tr_b16 v[128:129], v32 offset:8192
    ds_read_b64_tr_b16 v[130:131], v32 offset:10240
    s_waitcnt lgkmcnt(8)
    v_mfma_f32_16x16x32_bf16 v[52:55], v[112:115], v[196:199], v[52:55]
    v_mfma_f32_16x16x32_bf16 v[56:59], v[112:115], v[200:203], v[56:59]
    v_mfma_f32_16x16x32_bf16 v[60:63], v[112:115], v[204:207], v[60:63]
    v_mfma_f32_16x16x32_bf16 v[48:51], v[112:115], v[192:195], v[48:51]
    s_sub_u32 s100, 13, s99
    s_lshl_b32 s100, s100, 10
    buffer_load_dwordx4 v[240:243], v8, s[64:67], s100 offen sc1
    ds_read_b64_tr_b16 v[132:133], v33 offset:8192
    ds_read_b64_tr_b16 v[134:135], v33 offset:10240
    s_waitcnt lgkmcnt(8)
    v_mfma_f32_16x16x32_bf16 v[68:71], v[116:119], v[196:199], v[68:71]
    v_mfma_f32_16x16x32_bf16 v[72:75], v[116:119], v[200:203], v[72:75]
    v_mfma_f32_16x16x32_bf16 v[76:79], v[116:119], v[204:207], v[76:79]
    v_mfma_f32_16x16x32_bf16 v[64:67], v[116:119], v[192:195], v[64:67]
    buffer_load_dwordx4 v[244:247], v9, s[64:67], s100 offen sc1
    ds_read_b64_tr_b16 v[136:137], v34 offset:8192
    ds_read_b64_tr_b16 v[138:139], v34 offset:10240
    s_waitcnt lgkmcnt(8)
    v_mfma_f32_16x16x32_bf16 v[84:87], v[120:123], v[196:199], v[84:87]
    v_mfma_f32_16x16x32_bf16 v[88:91], v[120:123], v[200:203], v[88:91]
    v_mfma_f32_16x16x32_bf16 v[92:95], v[120:123], v[204:207], v[92:95]
    v_mfma_f32_16x16x32_bf16 v[80:83], v[120:123], v[192:195], v[80:83]
    buffer_load_dwordx4 v[248:251], v10, s[64:67], s100 offen sc1
    ds_read_b64_tr_b16 v[140:141], v35 offset:8192
    ds_read_b64_tr_b16 v[142:143], v35 offset:10240
    s_waitcnt lgkmcnt(8)
    v_mfma_f32_16x16x32_bf16 v[100:103], v[124:127], v[196:199], v[100:103]
    v_mfma_f32_16x16x32_bf16 v[104:107], v[124:127], v[200:203], v[104:107]
    v_mfma_f32_16x16x32_bf16 v[108:111], v[124:127], v[204:207], v[108:111]
    v_mfma_f32_16x16x32_bf16 v[96:99], v[124:127], v[192:195], v[96:99]
    buffer_load_dwordx4 v[252:255], v11, s[64:67], s100 offen sc1
    s_waitcnt vmcnt(8)
    ds_read_b64_tr_b16 v[112:113], v32 offset:12288
    ds_read_b64_tr_b16 v[114:115], v32 offset:14336
    s_waitcnt lgkmcnt(8)
    v_mfma_f32_16x16x32_bf16 v[52:55], v[128:131], v[212:215], v[52:55]
    v_mfma_f32_16x16x32_bf16 v[56:59], v[128:131], v[216:219], v[56:59]
    v_mfma_f32_16x16x32_bf16 v[60:63], v[128:131], v[220:223], v[60:63]
    v_mfma_f32_16x16x32_bf16 v[48:51], v[128:131], v[208:211], v[48:51]
    ds_read_b64_tr_b16 v[116:117], v33 offset:12288
    ds_read_b64_tr_b16 v[118:119], v33 offset:14336
    s_waitcnt lgkmcnt(8)
    v_mfma_f32_16x16x32_bf16 v[68:71], v[132:135], v[212:215], v[68:71]
    v_mfma_f32_16x16x32_bf16 v[72:75], v[132:135], v[216:219], v[72:75]
    v_mfma_f32_16x16x32_bf16 v[76:79], v[132:135], v[220:223], v[76:79]
    v_mfma_f32_16x16x32_bf16 v[64:67], v[132:135], v[208:211], v[64:67]
    ds_read_b64_tr_b16 v[120:121], v34 offset:12288
    ds_read_b64_tr_b16 v[122:123], v34 offset:14336
    s_waitcnt lgkmcnt(8)
    v_mfma_f32_16x16x32_bf16 v[84:87], v[136:139], v[212:215], v[84:87]
    v_mfma_f32_16x16x32_bf16 v[88:91], v[136:139], v[216:219], v[88:91]
    v_mfma_f32_16x16x32_bf16 v[92:95], v[136:139], v[220:223], v[92:95]
    v_mfma_f32_16x16x32_bf16 v[80:83], v[136:139], v[208:211], v[80:83]
    ds_read_b64_tr_b16 v[124:125], v35 offset:12288
    ds_read_b64_tr_b16 v[126:127], v35 offset:14336
    s_waitcnt lgkmcnt(8)
    v_mfma_f32_16x16x32_bf16 v[100:103], v[140:143], v[212:215], v[100:103]
    v_mfma_f32_16x16x32_bf16 v[104:107], v[140:143], v[216:219], v[104:107]
    v_mfma_f32_16x16x32_bf16 v[108:111], v[140:143], v[220:223], v[108:111]
    v_mfma_f32_16x16x32_bf16 v[96:99], v[140:143], v[208:211], v[96:99]
    s_waitcnt vmcnt(4)
    ds_read_b64_tr_b16 v[128:129], v32 offset:16384
    ds_read_b64_tr_b16 v[130:131], v32 offset:18432
    s_waitcnt lgkmcnt(8)
    v_mfma_f32_16x16x32_bf16 v[52:55], v[112:115], v[228:231], v[52:55]
    v_mfma_f32_16x16x32_bf16 v[56:59], v[112:115], v[232:235], v[56:59]
    v_mfma_f32_16x16x32_bf16 v[60:63], v[112:115], v[236:239], v[60:63]
    v_mfma_f32_16x16x32_bf16 v[48:51], v[112:115], v[224:227], v[48:51]
    ds_read_b64_tr_b16 v[132:133], v33 offset:16384
    ds_read_b64_tr_b16 v[134:135], v33 offset:18432
    s_waitcnt lgkmcnt(8)
    v_mfma_f32_16x16x32_bf16 v[68:71], v[116:119], v[228:231], v[68:71]
    v_mfma_f32_16x16x32_bf16 v[72:75], v[116:119], v[232:235], v[72:75]
    v_mfma_f32_16x16x32_bf16 v[76:79], v[116:119], v[236:239], v[76:79]
    v_mfma_f32_16x16x32_bf16 v[64:67], v[116:119], v[224:227], v[64:67]
    ds_read_b64_tr_b16 v[136:137], v34 offset:16384
    ds_read_b64_tr_b16 v[138:139], v34 offset:18432
    s_waitcnt lgkmcnt(8)
    v_mfma_f32_16x16x32_bf16 v[84:87], v[120:123], v[228:231], v[84:87]
    v_mfma_f32_16x16x32_bf16 v[88:91], v[120:123], v[232:235], v[88:91]
    v_mfma_f32_16x16x32_bf16 v[92:95], v[120:123], v[236:239], v[92:95]
    v_mfma_f32_16x16x32_bf16 v[80:83], v[120:123], v[224:227], v[80:83]
    ds_read_b64_tr_b16 v[140:141], v35 offset:16384
    ds_read_b64_tr_b16 v[142:143], v35 offset:18432
    s_waitcnt lgkmcnt(8)
    v_mfma_f32_16x16x32_bf16 v[100:103], v[124:127], v[228:231], v[100:103]
    v_mfma_f32_16x16x32_bf16 v[104:107], v[124:127], v[232:235], v[104:107]
    v_mfma_f32_16x16x32_bf16 v[108:111], v[124:127], v[236:239], v[108:111]
    v_mfma_f32_16x16x32_bf16 v[96:99], v[124:127], v[224:227], v[96:99]
    s_waitcnt vmcnt(0)
    s_waitcnt lgkmcnt(6)
    v_mfma_f32_16x16x32_bf16 v[52:55], v[128:131], v[244:247], v[52:55]
    v_mfma_f32_16x16x32_bf16 v[56:59], v[128:131], v[248:251], v[56:59]
    v_mfma_f32_16x16x32_bf16 v[60:63], v[128:131], v[252:255], v[60:63]
    v_mfma_f32_16x16x32_bf16 v[48:51], v[128:131], v[240:243], v[48:51]
    s_waitcnt lgkmcnt(4)
    v_mfma_f32_16x16x32_bf16 v[68:71], v[132:135], v[244:247], v[68:71]
    v_mfma_f32_16x16x32_bf16 v[72:75], v[132:135], v[248:251], v[72:75]
    v_mfma_f32_16x16x32_bf16 v[76:79], v[132:135], v[252:255], v[76:79]
    v_mfma_f32_16x16x32_bf16 v[64:67], v[132:135], v[240:243], v[64:67]
    s_waitcnt lgkmcnt(2)
    v_mfma_f32_16x16x32_bf16 v[84:87], v[136:139], v[244:247], v[84:87]
    v_mfma_f32_16x16x32_bf16 v[88:91], v[136:139], v[248:251], v[88:91]
    v_mfma_f32_16x16x32_bf16 v[92:95], v[136:139], v[252:255], v[92:95]
    v_mfma_f32_16x16x32_bf16 v[80:83], v[136:139], v[240:243], v[80:83]
    s_waitcnt lgkmcnt(0)
    v_mfma_f32_16x16x32_bf16 v[100:103], v[140:143], v[244:247], v[100:103]
    v_mfma_f32_16x16x32_bf16 v[104:107], v[140:143], v[248:251], v[104:107]
    v_mfma_f32_16x16x32_bf16 v[108:111], v[140:143], v[252:255], v[108:111]
    v_mfma_f32_16x16x32_bf16 v[96:99], v[140:143], v[240:243], v[96:99]
    v_add_u32 v16, s89, v3
    s_xor_b32 s76, s3, 1
    s_mul_i32 s76, s76, 36864
    s_add_u32 s76, s76, 0
    v_add_u32 v17, s76, v3
    s_xor_b32 s76, s3, 2
    s_mul_i32 s76, s76, 36864
    s_add_u32 s76, s76, 4096
    v_add_u32 v18, s76, v3
    s_xor_b32 s76, s3, 3
    s_mul_i32 s76, s76, 36864
    s_add_u32 s76, s76, 8192
    v_add_u32 v19, s76, v3
    ds_write_b128 v16, v[52:55] offset:0
    ds_write_b128 v16, v[68:71] offset:1024
    ds_write_b128 v16, v[84:87] offset:2048
    ds_write_b128 v16, v[100:103] offset:3072
    ds_write_b128 v16, v[56:59] offset:4096
    ds_write_b128 v16, v[72:75] offset:5120
    ds_write_b128 v16, v[88:91] offset:6144
    ds_write_b128 v16, v[104:107] offset:7168
    ds_write_b128 v16, v[60:63] offset:8192
    ds_write_b128 v16, v[76:79] offset:9216
    ds_write_b128 v16, v[92:95] offset:10240
    ds_write_b128 v16, v[108:111] offset:11264
    s_waitcnt lgkmcnt(0)
    s_barrier
    ds_read_b128 v[144:147], v17 offset:0
    ds_read_b128 v[148:151], v17 offset:1024
    ds_read_b128 v[152:155], v17 offset:2048
    ds_read_b128 v[156:159], v17 offset:3072
    ds_read_b128 v[160:163], v18 offset:0
    ds_read_b128 v[164:167], v18 offset:1024
    ds_read_b128 v[168:171], v18 offset:2048
    ds_read_b128 v[172:175], v18 offset:3072
    ds_read_b128 v[176:179], v19 offset:0
    ds_read_b128 v[180:183], v19 offset:1024
    ds_read_b128 v[184:187], v19 offset:2048
    ds_read_b128 v[188:191], v19 offset:3072
    s_waitcnt lgkmcnt(8)
    v_pk_add_f32 v[48:49], v[48:49], v[144:145]
    v_pk_add_f32 v[50:51], v[50:51], v[146:147]
    v_pk_add_f32 v[64:65], v[64:65], v[148:149]
    v_pk_add_f32 v[66:67], v[66:67], v[150:151]
    v_pk_add_f32 v[80:81], v[80:81], v[152:153]
    v_pk_add_f32 v[82:83], v[82:83], v[154:155]
    v_pk_add_f32 v[96:97], v[96:97], v[156:157]
    v_pk_add_f32 v[98:99], v[98:99], v[158:159]
    s_waitcnt lgkmcnt(4)
    v_pk_add_f32 v[48:49], v[48:49], v[160:161]
    v_pk_add_f32 v[50:51], v[50:51], v[162:163]
    v_pk_add_f32 v[64:65], v[64:65], v[164:165]
    v_pk_add_f32 v[66:67], v[66:67], v[166:167]
    v_pk_add_f32 v[80:81], v[80:81], v[168:169]
    v_pk_add_f32 v[82:83], v[82:83], v[170:171]
    v_pk_add_f32 v[96:97], v[96:97], v[172:173]
    v_pk_add_f32 v[98:99], v[98:99], v[174:175]
    s_waitcnt lgkmcnt(0)
    v_pk_add_f32 v[48:49], v[48:49], v[176:177]
    v_pk_add_f32 v[50:51], v[50:51], v[178:179]
    v_pk_add_f32 v[64:65], v[64:65], v[180:181]
    v_pk_add_f32 v[66:67], v[66:67], v[182:183]
    v_pk_add_f32 v[80:81], v[80:81], v[184:185]
    v_pk_add_f32 v[82:83], v[82:83], v[186:187]
    v_pk_add_f32 v[96:97], v[96:97], v[188:189]
    v_pk_add_f32 v[98:99], v[98:99], v[190:191]
    v_cvt_pk_bf16_f32 v112, v48, v49
    v_cvt_pk_bf16_f32 v113, v50, v51
    v_cvt_pk_bf16_f32 v114, v64, v65
    v_cvt_pk_bf16_f32 v115, v66, v67
    v_cvt_pk_bf16_f32 v116, v80, v81
    v_cvt_pk_bf16_f32 v117, v82, v83
    v_cvt_pk_bf16_f32 v118, v96, v97
    v_cvt_pk_bf16_f32 v119, v98, v99
    s_nop 1
    v_permlane32_swap_b32 v112, v116
    v_permlane32_swap_b32 v114, v118
    v_permlane32_swap_b32 v113, v117
    v_permlane32_swap_b32 v115, v119
    s_nop 1
    v_permlane16_swap_b32 v112, v114
    v_permlane16_swap_b32 v116, v118
    v_permlane16_swap_b32 v113, v115
    v_permlane16_swap_b32 v117, v119
    s_nop 1
    buffer_store_dwordx4 v[112:115], v20, s[40:43], 0 offen nt
    buffer_store_dwordx4 v[116:119], v20, s[40:43], 0 offen offset:16 nt
    s_branch L_end
L_helper:
    s_lshl_b32 s76, s7, 6
    s_lshl_b32 s77, s3, 4
    s_add_u32 s76, s76, s77
    v_add_u32 v4, 0, v1
    v_xor_b32 v5, v4, v2
    v_add_u32 v4, s76, v4
    v_lshlrev_b32 v5, 4, v5
    v_lshl_add_u32 v8, v4, 10, v5
    v_cmp_eq_u32 vcc, 0, v4
    v_add_u32 v12, 0x40000, v8
    s_nop 0
    v_cndmask_b32 v12, v8, v12, vcc
    v_add_u32 v4, 4, v1
    v_xor_b32 v5, v4, v2
    v_add_u32 v4, s76, v4
    v_lshlrev_b32 v5, 4, v5
    v_lshl_add_u32 v9, v4, 10, v5
    v_add_u32 v4, 8, v1
    v_xor_b32 v5, v4, v2
    v_add_u32 v4, s76, v4
    v_lshlrev_b32 v5, 4, v5
    v_lshl_add_u32 v10, v4, 10, v5
    v_add_u32 v4, 12, v1
    v_xor_b32 v5, v4, v2
    v_add_u32 v4, s76, v4
    v_lshlrev_b32 v5, 4, v5
    v_lshl_add_u32 v11, v4, 10, v5
    s_waitcnt lgkmcnt(0)
    s_mov_b32 s28, s52
    s_mov_b32 s29, s53
    s_mov_b32 s30, 524288
    s_mov_b32 s31, 0x20000
    s_mov_b32 s24, s50
    s_mov_b32 s25, s51
    s_mov_b32 s26, 524288
    s_mov_b32 s27, 0x20000
    s_add_u32 m0, s87, 32768
    s_nop 0
    buffer_load_dwordx4 v12, s[24:27], 0 offen lds
    s_add_u32 m0, s87, 33792
    s_nop 0
    buffer_load_dwordx4 v9, s[24:27], 0 offen lds
    s_add_u32 m0, s87, 34816
    s_nop 0
    buffer_load_dwordx4 v10, s[24:27], 0 offen lds
    s_add_u32 m0, s87, 35840
    s_nop 0
    buffer_load_dwordx4 v11, s[24:27], 0 offen lds
    s_add_u32 m0, s87, 36864
    s_nop 0
    buffer_load_dwordx4 v8, s[28:31], 0 offen lds
    s_add_u32 m0, s87, 37888
    s_nop 0
    buffer_load_dwordx4 v9, s[28:31], 0 offen lds
    s_add_u32 m0, s87, 38912
    s_nop 0
    buffer_load_dwordx4 v10, s[28:31], 0 offen lds
    s_add_u32 m0, s87, 39936
    s_nop 0
    buffer_load_dwordx4 v11, s[28:31], 0 offen lds
    s_and_b32 s76, s2, 7
    s_lshr_b32 s77, s2, 3
    s_and_b32 s78, s77, 1
    s_lshl_b32 s4, s76, 1
    s_add_u32 s4, s4, s78
    s_lshr_b32 s5, s77, 1
    s_and_b32 s78, s5, 1
    s_lshl_b32 s8, s4, 1
    s_add_u32 s8, s8, s78
    s_lshr_b32 s9, s5, 1
    s_lshr_b32 s10, s8, 4
    s_and_b32 s11, s8, 15
    s_mov_b32 s80, 4096
    s_mov_b32 s81, 8192
    s_mov_b32 s82, 12288
    s_mov_b32 s83, 0x3f803f80
    s_mov_b32 s84, 0xffff0000
    s_mov_b32 s92, -1
    s_mov_b32 s93, 0x00ffffff
    s_and_b32 s98, s4, 14
    s_mul_i32 s98, s98, 1
    s_bfe_u32 s76, s4, 0x10001
    s_mul_i32 s99, s76, 7
    s_mov_b32 s68, s62
    s_mov_b32 s69, s63
    s_mov_b32 s70, 256
    s_mov_b32 s71, 0x20000
    s_cmp_eq_u32 s10, 0
    s_cselect_b32 s72, s46, s48
    s_cselect_b32 s73, s47, s49
    s_mov_b32 s74, 8388608
    s_mov_b32 s75, 0x20000
    s_mov_b32 s40, s60
    s_mov_b32 s41, s61
    s_mov_b32 s42, 2097152
    s_mov_b32 s43, 0x20000
    s_mov_b32 s36, s58
    s_mov_b32 s37, s59
    s_mov_b32 s38, 1835008
    s_mov_b32 s39, 0x20000
    s_mov_b32 s32, s56
    s_mov_b32 s33, s57
    s_mov_b32 s34, 1835008
    s_mov_b32 s35, 0x20000
    s_mov_b32 s20, s48
    s_mov_b32 s21, s49
    s_mov_b32 s22, 8388608
    s_mov_b32 s23, 0x20000
    s_mov_b32 s16, s46
    s_mov_b32 s17, s47
    s_mov_b32 s18, 8388608
    s_mov_b32 s19, 0x20000
    s_mov_b32 s12, s44
    s_mov_b32 s13, s45
    s_mov_b32 s14, 2097152
    s_mov_b32 s15, 0x20000
    s_add_u32 s52, s96, 1114112
    s_addc_u32 s53, s97, 0
    s_mov_b32 s54, 32768
    s_mov_b32 s55, 0x20000
    s_lshl_b32 s79, s2, 2
    s_add_u32 s79, s79, s3
    s_cmp_lg_u32 s79, 3
    s_cbranch_scc1 L_noleader2
    v_lshlrev_b32 v4, 8, v0
    v_mov_b32 v5, 0
    s_mov_b32 s76, 16384
    buffer_store_dword v5, v4, s[52:55], 0 offen sc1
    buffer_store_dword v5, v4, s[52:55], s76 offen sc1
    s_waitcnt vmcnt(0)
    v_mov_b32 v4, 1
    s_mov_b64 exec, 1
    buffer_store_dword v4, v5, s[68:71], 0 offen sc1
    s_mov_b64 exec, -1
L_noleader2:
    s_lshl_b32 s76, s11, 6
    s_add_u32 s76, s76, s10
    s_and_b32 s77, s3, 1
    s_lshl_b32 s77, s77, 5
    s_add_u32 s85, s76, s77
    s_lshl_b32 s88, s85, 12
    s_lshl_b32 s89, s3, 14
    s_cmp_ge_u32 s3, 2
    s_cselect_b32 s24, s20, s16
    s_cselect_b32 s25, s21, s17
    s_mov_b32 s26, 8388608
    s_lshl_b32 s76, s9, 6
    s_sub_u32 s77, 896, s76
    s_cmp_ge_u32 s3, 2
    s_cselect_b64 s[94:95], -1, 0
    v_add_u32 v4, 0, v1
    v_xor_b32 v5, v4, v2
    v_lshl_add_u32 v4, v4, 1, s85
    v_sub_u32 v6, 0x800, v4
    v_cmp_eq_u32 vcc, 0, v4
    v_mov_b32 v7, 0x400
    v_lshlrev_b32 v13, 4, v5
    v_cndmask_b32 v6, v6, v7, vcc
    v_cndmask_b32 v4, v4, v6, s[94:95]
    v_add_u32 v6, s76, v13
    v_add_u32 v7, s77, v13
    v_cmp_lt_u32 vcc, 3, v5
    v_mov_b32 v13, 512
    s_nop 0
    v_cndmask_b32 v6, v6, v7, vcc
    v_cmp_lt_u32 vcc, 8, v5
    s_nop 1
    v_cndmask_b32 v6, v6, v13, vcc
    v_lshl_add_u32 v8, v4, 10, v6
    v_add_u32 v4, 4, v1
    v_xor_b32 v5, v4, v2
    v_lshl_add_u32 v4, v4, 1, s85
    v_sub_u32 v6, 0x800, v4
    v_cmp_eq_u32 vcc, 0, v4
    v_mov_b32 v7, 0x400
    v_lshlrev_b32 v13, 4, v5
    v_cndmask_b32 v6, v6, v7, vcc
    v_cndmask_b32 v4, v4, v6, s[94:95]
    v_add_u32 v6, s76, v13
    v_add_u32 v7, s77, v13
    v_cmp_lt_u32 vcc, 3, v5
    v_mov_b32 v13, 512
    s_nop 0
    v_cndmask_b32 v6, v6, v7, vcc
    v_cmp_lt_u32 vcc, 8, v5
    s_nop 1
    v_cndmask_b32 v6, v6, v13, vcc
    v_lshl_add_u32 v9, v4, 10, v6
    v_add_u32 v4, 8, v1
    v_xor_b32 v5, v4, v2
    v_lshl_add_u32 v4, v4, 1, s85
    v_sub_u32 v6, 0x800, v4
    v_cmp_eq_u32 vcc, 0, v4
    v_mov_b32 v7, 0x400
    v_lshlrev_b32 v13, 4, v5
    v_cndmask_b32 v6, v6, v7, vcc
    v_cndmask_b32 v4, v4, v6, s[94:95]
    v_add_u32 v6, s76, v13
    v_add_u32 v7, s77, v13
    v_cmp_lt_u32 vcc, 3, v5
    v_mov_b32 v13, 512
    s_nop 0
    v_cndmask_b32 v6, v6, v7, vcc
    v_cmp_lt_u32 vcc, 8, v5
    s_nop 1
    v_cndmask_b32 v6, v6, v13, vcc
    v_lshl_add_u32 v10, v4, 10, v6
    v_add_u32 v4, 12, v1
    v_xor_b32 v5, v4, v2
    v_lshl_add_u32 v4, v4, 1, s85
    v_sub_u32 v6, 0x800, v4
    v_cmp_eq_u32 vcc, 0, v4
    v_mov_b32 v7, 0x400
    v_lshlrev_b32 v13, 4, v5
    v_cndmask_b32 v6, v6, v7, vcc
    v_cndmask_b32 v4, v4, v6, s[94:95]
    v_add_u32 v6, s76, v13
    v_add_u32 v7, s77, v13
    v_cmp_lt_u32 vcc, 3, v5
    v_mov_b32 v13, 512
    s_nop 0
    v_cndmask_b32 v6, v6, v7, vcc
    v_cmp_lt_u32 vcc, 8, v5
    s_nop 1
    v_cndmask_b32 v6, v6, v13, vcc
    v_lshl_add_u32 v11, v4, 10, v6
    s_lshl_b32 s86, s3, 12
    v_mul_u32_u24 v4, 0x4925, v0
    v_lshrrev_b32 v4, 18, v4
    v_mul_u32_u24 v5, 14, v4
    v_sub_u32 v5, v0, v5
    s_mul_i32 s76, s5, 224
    v_lshl_add_u32 v5, v5, 4, s76
    v_mul_u32_u24 v6, 3584, v4
    v_add_u32 v14, v5, v6
    v_sub_u32 v15, 10752, v6
    v_add_u32 v15, v5, v15
    v_sub_u32 v16, 917504, v6
    v_cmp_eq_u32 vcc, 0, v4
    v_add_u32 v16, v5, v16
    s_mul_i32 s91, s3, 7168
    s_add_u32 s90, s98, s3
    v_cndmask_b32 v16, v16, v5, vcc
    s_and_b32 s78, s5, 1
    s_lshl_b32 s76, s78, 5
    s_cmp_eq_u32 s78, 0
    s_cselect_b32 s77, 192, 0
    s_add_u32 s76, s76, s91
    s_add_u32 s77, s77, s91
    v_lshrrev_b32 v4, 2, v0
    v_mul_u32_u24 v4, 224, v4
    v_and_b32 v5, 3, v0
    v_lshl_add_u32 v4, v5, 3, v4
    v_add_u32 v19, s76, v4
    v_add_u32 v20, s77, v4
    v_add_u32 v21, s91, v3
    v_add_u32 v22, 57344, v19
    v_add_u32 v23, 57344, v20
    v_add_u32 v24, 57344, v21
    s_mul_i32 s76, s3, 448
    s_add_u32 s76, s76, 151552
    v_lshl_add_u32 v25, v1, 4, s76
    v_mov_b32 v252, s83
    v_mov_b32 v253, s83
    v_mov_b32 v254, s83
    v_mov_b32 v255, s83
    v_bfe_u32 v4, v0, 1, 2
    v_xor_b32 v4, v4, v1
    v_and_b32 v5, 1, v0
    v_lshl_or_b32 v4, v4, 1, v5
    v_lshrrev_b32 v5, 3, v0
    v_lshlrev_b32 v5, 10, v5
    v_lshl_add_u32 v4, v4, 4, v5
    s_lshl_b32 s76, s9, 7
    s_mul_i32 s77, s3, 458752
    s_add_u32 s76, s76, s77
    v_add_u32 v17, s76, v4
    s_mul_i32 s76, s3, 36864
    v_add_u32 v18, s76, v3
    v_mov_b32 v28, 163584
    v_mov_b32 v29, 1
    s_lshl_b32 s76, s3, 2
    v_add_u32 v30, s76, v28
    v_lshl_add_u32 v4, v0, 2, v28
    v_mov_b32 v5, 0
    ds_write_b32 v4, v5
    v_lshrrev_b32 v4, 2, v2
    v_and_b32 v5, 3, v2
    v_xor_b32 v5, v5, v1
    v_lshlrev_b32 v5, 4, v5
    v_lshl_add_u32 v5, v2, 10, v5
    s_and_b32 s76, s3, 1
    s_lshl_b32 s77, s76, 14
    v_add_u32 v5, s77, v5
    v_xor_b32 v6, 0, v4
    v_lshl_add_u32 v100, v6, 6, v5
    v_xor_b32 v6, 1, v4
    v_lshl_add_u32 v101, v6, 6, v5
    v_xor_b32 v6, 2, v4
    v_lshl_add_u32 v102, v6, 6, v5
    v_xor_b32 v6, 3, v4
    v_lshl_add_u32 v103, v6, 6, v5
    s_lshl_b32 s76, s76, 6
    s_add_u32 s76, s76, 65536
    v_lshl_add_u32 v104, v1, 4, s76
    v_lshl_add_u32 v105, v2, 2, s76
    v_cmp_eq_u32 s[56:57], v4, v1
    v_and_b32 v106, 3, v2
    s_add_u32 s76, s88, 0
    s_add_u32 m0, s89, 98048
    v_xor_b32 v4, 0, v3
    buffer_load_dwordx4 v4, s[24:27], s76 offen lds
    s_add_u32 s76, s88, 8192
    s_add_u32 m0, s89, 99072
    v_xor_b32 v4, 16, v3
    buffer_load_dwordx4 v4, s[24:27], s76 offen lds
    s_waitcnt vmcnt(2)
    s_waitcnt lgkmcnt(0)
    s_barrier
    ds_read_b128 v[32:35], v100 offset:0
    ds_read_b128 v[36:39], v101 offset:0
    ds_read_b128 v[40:43], v102 offset:0
    ds_read_b128 v[44:47], v103 offset:0
    ds_read_b128 v[48:51], v100 offset:256
    ds_read_b128 v[52:55], v101 offset:256
    ds_read_b128 v[56:59], v102 offset:256
    ds_read_b128 v[60:63], v103 offset:256
    ds_read_b128 v[64:67], v100 offset:512
    ds_read_b128 v[68:71], v101 offset:512
    ds_read_b128 v[72:75], v102 offset:512
    ds_read_b128 v[76:79], v103 offset:512
    ds_read_b128 v[80:83], v100 offset:768
    ds_read_b128 v[84:87], v101 offset:768
    ds_read_b128 v[88:91], v102 offset:768
    ds_read_b128 v[92:95], v103 offset:768
    s_cmp_ge_u32 s3, 2
    s_cbranch_scc1 L_h_sq
    s_waitcnt lgkmcnt(15)
    v_mfma_f32_16x16x32_bf16 v[96:99], v[32:35], v[252:255], 0
    s_waitcnt lgkmcnt(14)
    v_mfma_f32_16x16x32_bf16 v[96:99], v[36:39], v[252:255], v[96:99]
    s_waitcnt lgkmcnt(13)
    v_mfma_f32_16x16x32_bf16 v[96:99], v[40:43], v[252:255], v[96:99]
    s_waitcnt lgkmcnt(12)
    v_mfma_f32_16x16x32_bf16 v[96:99], v[44:47], v[252:255], v[96:99]
    s_waitcnt lgkmcnt(11)
    v_mfma_f32_16x16x32_bf16 v[96:99], v[48:51], v[252:255], v[96:99]
    s_waitcnt lgkmcnt(10)
    v_mfma_f32_16x16x32_bf16 v[96:99], v[52:55], v[252:255], v[96:99]
    s_waitcnt lgkmcnt(9)
    v_mfma_f32_16x16x32_bf16 v[96:99], v[56:59], v[252:255], v[96:99]
    s_waitcnt lgkmcnt(8)
    v_mfma_f32_16x16x32_bf16 v[96:99], v[60:63], v[252:255], v[96:99]
    s_waitcnt lgkmcnt(7)
    v_mfma_f32_16x16x32_bf16 v[96:99], v[64:67], v[252:255], v[96:99]
    s_waitcnt lgkmcnt(6)
    v_mfma_f32_16x16x32_bf16 v[96:99], v[68:71], v[252:255], v[96:99]
    s_waitcnt lgkmcnt(5)
    v_mfma_f32_16x16x32_bf16 v[96:99], v[72:75], v[252:255], v[96:99]
    s_waitcnt lgkmcnt(4)
    v_mfma_f32_16x16x32_bf16 v[96:99], v[76:79], v[252:255], v[96:99]
    s_waitcnt lgkmcnt(3)
    v_mfma_f32_16x16x32_bf16 v[96:99], v[80:83], v[252:255], v[96:99]
    s_waitcnt lgkmcnt(2)
    v_mfma_f32_16x16x32_bf16 v[96:99], v[84:87], v[252:255], v[96:99]
    s_waitcnt lgkmcnt(1)
    v_mfma_f32_16x16x32_bf16 v[96:99], v[88:91], v[252:255], v[96:99]
    s_waitcnt lgkmcnt(0)
    v_mfma_f32_16x16x32_bf16 v[96:99], v[92:95], v[252:255], v[96:99]
    s_nop 7
    s_mov_b32 exec_lo, 0x00010001
    s_mov_b32 exec_hi, 0x00010001
    ds_write_b128 v104, v[96:99]
    s_branch L_h_stat_done
L_h_sq:
    s_waitcnt lgkmcnt(15)
    v_mfma_f32_16x16x32_bf16 v[96:99], v[32:35], v[32:35], 0
    s_waitcnt lgkmcnt(14)
    v_mfma_f32_16x16x32_bf16 v[96:99], v[36:39], v[36:39], v[96:99]
    s_waitcnt lgkmcnt(13)
    v_mfma_f32_16x16x32_bf16 v[96:99], v[40:43], v[40:43], v[96:99]
    s_waitcnt lgkmcnt(12)
    v_mfma_f32_16x16x32_bf16 v[96:99], v[44:47], v[44:47], v[96:99]
    s_waitcnt lgkmcnt(11)
    v_mfma_f32_16x16x32_bf16 v[96:99], v[48:51], v[48:51], v[96:99]
    s_waitcnt lgkmcnt(10)
    v_mfma_f32_16x16x32_bf16 v[96:99], v[52:55], v[52:55], v[96:99]
    s_waitcnt lgkmcnt(9)
    v_mfma_f32_16x16x32_bf16 v[96:99], v[56:59], v[56:59], v[96:99]
    s_waitcnt lgkmcnt(8)
    v_mfma_f32_16x16x32_bf16 v[96:99], v[60:63], v[60:63], v[96:99]
    s_waitcnt lgkmcnt(7)
    v_mfma_f32_16x16x32_bf16 v[96:99], v[64:67], v[64:67], v[96:99]
    s_waitcnt lgkmcnt(6)
    v_mfma_f32_16x16x32_bf16 v[96:99], v[68:71], v[68:71], v[96:99]
    s_waitcnt lgkmcnt(5)
    v_mfma_f32_16x16x32_bf16 v[96:99], v[72:75], v[72:75], v[96:99]
    s_waitcnt lgkmcnt(4)
    v_mfma_f32_16x16x32_bf16 v[96:99], v[76:79], v[76:79], v[96:99]
    s_waitcnt lgkmcnt(3)
    v_mfma_f32_16x16x32_bf16 v[96:99], v[80:83], v[80:83], v[96:99]
    s_waitcnt lgkmcnt(2)
    v_mfma_f32_16x16x32_bf16 v[96:99], v[84:87], v[84:87], v[96:99]
    s_waitcnt lgkmcnt(1)
    v_mfma_f32_16x16x32_bf16 v[96:99], v[88:91], v[88:91], v[96:99]
    s_waitcnt lgkmcnt(0)
    v_mfma_f32_16x16x32_bf16 v[96:99], v[92:95], v[92:95], v[96:99]
    v_cmp_eq_u32 vcc, 1, v106
    v_cmp_eq_u32 s[94:95], 2, v106
    v_cmp_eq_u32 s[58:59], 3, v106
    s_nop 5
    v_cndmask_b32 v96, v96, v97, vcc
    v_cndmask_b32 v96, v96, v98, s[94:95]
    v_cndmask_b32 v96, v96, v99, s[58:59]
    s_mov_b64 exec, s[56:57]
    ds_write_b32 v105, v96 offset:128
L_h_stat_done:
    s_mov_b64 exec, -1
    s_add_u32 s76, s88, 16384
    s_add_u32 m0, s89, 100096
    v_xor_b32 v4, 32, v3
    buffer_load_dwordx4 v4, s[24:27], s76 offen lds
    s_add_u32 s76, s88, 24576
    s_add_u32 m0, s89, 101120
    v_xor_b32 v4, 48, v3
    buffer_load_dwordx4 v4, s[24:27], s76 offen lds
    s_waitcnt lgkmcnt(0)
    s_barrier
    s_add_u32 s76, s88, 32768
    s_add_u32 m0, s89, 102144
    v_xor_b32 v4, 64, v3
    buffer_load_dwordx4 v4, s[24:27], s76 offen lds
    s_add_u32 s76, s88, 40960
    s_add_u32 m0, s89, 103168
    v_xor_b32 v4, 80, v3
    buffer_load_dwordx4 v4, s[24:27], s76 offen lds
    s_add_u32 s76, s88, 49152
    s_add_u32 m0, s89, 104192
    v_xor_b32 v4, 96, v3
    buffer_load_dwordx4 v4, s[24:27], s76 offen lds
    s_add_u32 s76, s88, 57344
    s_add_u32 m0, s89, 105216
    v_xor_b32 v4, 112, v3
    buffer_load_dwordx4 v4, s[24:27], s76 offen lds
    s_add_u32 s76, s88, 65536
    s_add_u32 m0, s89, 106240
    v_xor_b32 v4, 128, v3
    buffer_load_dwordx4 v4, s[24:27], s76 offen lds
    s_add_u32 s76, s88, 73728
    s_add_u32 m0, s89, 107264
    v_xor_b32 v4, 144, v3
    buffer_load_dwordx4 v4, s[24:27], s76 offen lds
    s_add_u32 s76, s88, 81920
    s_add_u32 m0, s89, 108288
    v_xor_b32 v4, 160, v3
    buffer_load_dwordx4 v4, s[24:27], s76 offen lds
    s_add_u32 s76, s88, 90112
    s_add_u32 m0, s89, 109312
    v_xor_b32 v4, 176, v3
    buffer_load_dwordx4 v4, s[24:27], s76 offen lds
    s_add_u32 s76, s88, 98304
    s_add_u32 m0, s89, 110336
    v_xor_b32 v4, 192, v3
    buffer_load_dwordx4 v4, s[24:27], s76 offen lds
    s_add_u32 s76, s88, 106496
    s_add_u32 m0, s89, 111360
    v_xor_b32 v4, 208, v3
    buffer_load_dwordx4 v4, s[24:27], s76 offen lds
    s_add_u32 s76, s88, 114688
    s_add_u32 m0, s89, 112384
    v_xor_b32 v4, 224, v3
    buffer_load_dwordx4 v4, s[24:27], s76 offen lds
    s_add_u32 s76, s88, 122880
    s_add_u32 m0, s89, 113408
    v_xor_b32 v4, 240, v3
    buffer_load_dwordx4 v4, s[24:27], s76 offen lds
    s_add_u32 m0, s86, 81664
    s_nop 0
    buffer_load_dwordx4 v8, s[12:15], 0 offen lds
    s_add_u32 m0, s86, 82688
    s_nop 0
    buffer_load_dwordx4 v9, s[12:15], 0 offen lds
    s_add_u32 m0, s86, 83712
    s_nop 0
    buffer_load_dwordx4 v10, s[12:15], 0 offen lds
    s_add_u32 m0, s86, 84736
    s_nop 0
    buffer_load_dwordx4 v11, s[12:15], 0 offen lds
    s_add_u32 s78, s90, 0
    s_and_b32 s78, s78, 15
    s_mul_i32 s100, s78, 57344
    s_mov_b64 exec, s[92:93]
    s_add_u32 m0, s91, 0
    s_add_u32 s76, s100, 0
    buffer_load_dwordx4 v14, s[32:35], s76 offen lds
    s_mov_b64 exec, -1
    s_mov_b64 exec, s[92:93]
    s_add_u32 m0, s91, 896
    s_add_u32 s76, s100, 14336
    buffer_load_dwordx4 v14, s[32:35], s76 offen lds
    s_mov_b64 exec, -1
    s_mov_b64 exec, s[92:93]
    s_add_u32 m0, s91, 1792
    s_add_u32 s76, s100, 28672
    buffer_load_dwordx4 v14, s[32:35], s76 offen lds
    s_mov_b64 exec, -1
    s_mov_b64 exec, s[92:93]
    s_add_u32 m0, s91, 2688
    s_add_u32 s76, s100, 43008
    buffer_load_dwordx4 v14, s[32:35], s76 offen lds
    s_mov_b64 exec, -1
    s_waitcnt vmcnt(4)
    s_mov_b64 exec, 1
    ds_add_u32 v28, v29 offset:0
    s_mov_b64 exec, -1
    s_mov_b64 exec, s[92:93]
    s_add_u32 m0, s91, 3584
    s_sub_u32 s76, 1824256, s100
    s_cmp_eq_u32 s100, 0
    s_cselect_b32 s76, 917504, s76
    s_cselect_b64 s[94:95], -1, 0
    v_cndmask_b32 v4, v15, v16, s[94:95]
    buffer_load_dwordx4 v4, s[32:35], s76 offen lds
    s_mov_b64 exec, -1
    s_mov_b64 exec, s[92:93]
    s_add_u32 m0, s91, 4480
    s_sub_u32 s76, 1809920, s100
    buffer_load_dwordx4 v15, s[32:35], s76 offen lds
    s_mov_b64 exec, -1
    s_mov_b64 exec, s[92:93]
    s_add_u32 m0, s91, 5376
    s_sub_u32 s76, 1795584, s100
    buffer_load_dwordx4 v15, s[32:35], s76 offen lds
    s_mov_b64 exec, -1
    s_mov_b64 exec, s[92:93]
    s_add_u32 m0, s91, 6272
    s_sub_u32 s76, 1781248, s100
    buffer_load_dwordx4 v15, s[32:35], s76 offen lds
    s_mov_b64 exec, -1
    s_add_u32 s78, s90, 4
    s_and_b32 s78, s78, 15
    s_mul_i32 s100, s78, 57344
    s_mov_b64 exec, s[92:93]
    s_add_u32 m0, s91, 28672
    s_add_u32 s76, s100, 0
    buffer_load_dwordx4 v14, s[32:35], s76 offen lds
    s_mov_b64 exec, -1
    s_mov_b64 exec, s[92:93]
    s_add_u32 m0, s91, 29568
    s_add_u32 s76, s100, 14336
    buffer_load_dwordx4 v14, s[32:35], s76 offen lds
    s_mov_b64 exec, -1
    s_mov_b64 exec, s[92:93]
    s_add_u32 m0, s91, 30464
    s_add_u32 s76, s100, 28672
    buffer_load_dwordx4 v14, s[32:35], s76 offen lds
    s_mov_b64 exec, -1
    s_mov_b64 exec, s[92:93]
    s_add_u32 m0, s91, 31360
    s_add_u32 s76, s100, 43008
    buffer_load_dwordx4 v14, s[32:35], s76 offen lds
    s_mov_b64 exec, -1
    s_mov_b64 exec, s[92:93]
    s_add_u32 m0, s91, 32256
    s_sub_u32 s76, 1824256, s100
    s_cmp_eq_u32 s100, 0
    s_cselect_b32 s76, 917504, s76
    s_cselect_b64 s[94:95], -1, 0
    v_cndmask_b32 v4, v15, v16, s[94:95]
    buffer_load_dwordx4 v4, s[32:35], s76 offen lds
    s_mov_b64 exec, -1
    s_mov_b64 exec, s[92:93]
    s_add_u32 m0, s91, 33152
    s_sub_u32 s76, 1809920, s100
    buffer_load_dwordx4 v15, s[32:35], s76 offen lds
    s_mov_b64 exec, -1
    s_mov_b64 exec, s[92:93]
    s_add_u32 m0, s91, 34048
    s_sub_u32 s76, 1795584, s100
    buffer_load_dwordx4 v15, s[32:35], s76 offen lds
    s_mov_b64 exec, -1
    s_mov_b64 exec, s[92:93]
    s_add_u32 m0, s91, 34944
    s_sub_u32 s76, 1781248, s100
    buffer_load_dwordx4 v15, s[32:35], s76 offen lds
    s_mov_b64 exec, -1
    s_add_u32 s78, s90, 8
    s_and_b32 s78, s78, 15
    s_mul_i32 s100, s78, 57344
    s_mov_b64 exec, s[92:93]
    s_add_u32 s76, s100, 0
    buffer_load_dwordx4 v[132:135], v14, s[32:35], s76 offen
    s_mov_b64 exec, -1
    s_mov_b64 exec, s[92:93]
    s_add_u32 s76, s100, 14336
    buffer_load_dwordx4 v[136:139], v14, s[32:35], s76 offen
    s_mov_b64 exec, -1
    s_mov_b64 exec, s[92:93]
    s_add_u32 s76, s100, 28672
    buffer_load_dwordx4 v[140:143], v14, s[32:35], s76 offen
    s_mov_b64 exec, -1
    s_mov_b64 exec, s[92:93]
    s_add_u32 s76, s100, 43008
    buffer_load_dwordx4 v[144:147], v14, s[32:35], s76 offen
    s_mov_b64 exec, -1
    s_mov_b64 exec, s[92:93]
    s_sub_u32 s76, 1824256, s100
    s_cmp_eq_u32 s100, 0
    s_cselect_b32 s76, 917504, s76
    s_cselect_b64 s[94:95], -1, 0
    v_cndmask_b32 v4, v15, v16, s[94:95]
    buffer_load_dwordx4 v[148:151], v4, s[32:35], s76 offen
    s_mov_b64 exec, -1
    s_mov_b64 exec, s[92:93]
    s_sub_u32 s76, 1809920, s100
    buffer_load_dwordx4 v[152:155], v15, s[32:35], s76 offen
    s_mov_b64 exec, -1
    s_mov_b64 exec, s[92:93]
    s_sub_u32 s76, 1795584, s100
    buffer_load_dwordx4 v[156:159], v15, s[32:35], s76 offen
    s_mov_b64 exec, -1
    s_mov_b64 exec, s[92:93]
    s_sub_u32 s76, 1781248, s100
    buffer_load_dwordx4 v[160:163], v15, s[32:35], s76 offen
    s_mov_b64 exec, -1
    s_add_u32 s78, s90, 12
    s_and_b32 s78, s78, 15
    s_mul_i32 s100, s78, 57344
    s_mov_b64 exec, s[92:93]
    s_add_u32 s76, s100, 0
    buffer_load_dwordx4 v[164:167], v14, s[32:35], s76 offen
    s_mov_b64 exec, -1
    s_mov_b64 exec, s[92:93]
    s_add_u32 s76, s100, 14336
    buffer_load_dwordx4 v[168:171], v14, s[32:35], s76 offen
    s_mov_b64 exec, -1
    s_mov_b64 exec, s[92:93]
    s_add_u32 s76, s100, 28672
    buffer_load_dwordx4 v[172:175], v14, s[32:35], s76 offen
    s_mov_b64 exec, -1
    s_mov_b64 exec, s[92:93]
    s_add_u32 s76, s100, 43008
    buffer_load_dwordx4 v[176:179], v14, s[32:35], s76 offen
    s_mov_b64 exec, -1
    s_mov_b64 exec, s[92:93]
    s_sub_u32 s76, 1824256, s100
    s_cmp_eq_u32 s100, 0
    s_cselect_b32 s76, 917504, s76
    s_cselect_b64 s[94:95], -1, 0
    v_cndmask_b32 v4, v15, v16, s[94:95]
    buffer_load_dwordx4 v[180:183], v4, s[32:35], s76 offen
    s_mov_b64 exec, -1
    s_mov_b64 exec, s[92:93]
    s_sub_u32 s76, 1809920, s100
    buffer_load_dwordx4 v[184:187], v15, s[32:35], s76 offen
    s_mov_b64 exec, -1
    s_mov_b64 exec, s[92:93]
    s_sub_u32 s76, 1795584, s100
    buffer_load_dwordx4 v[188:191], v15, s[32:35], s76 offen
    s_mov_b64 exec, -1
    s_mov_b64 exec, s[92:93]
    s_sub_u32 s76, 1781248, s100
    buffer_load_dwordx4 v[192:195], v15, s[32:35], s76 offen
    s_mov_b64 exec, -1
    s_waitcnt vmcnt(24)
    ds_read_b64_tr_b16 v[196:197], v19 offset:0
    ds_read_b64_tr_b16 v[198:199], v19 offset:3584
    ds_read_b64_tr_b16 v[200:201], v19 offset:32
    ds_read_b64_tr_b16 v[202:203], v19 offset:3616
    ds_read_b64_tr_b16 v[204:205], v19 offset:64
    ds_read_b64_tr_b16 v[206:207], v19 offset:3648
    ds_read_b64_tr_b16 v[208:209], v19 offset:96
    ds_read_b64_tr_b16 v[210:211], v19 offset:3680
    ds_read_b64_tr_b16 v[212:213], v19 offset:128
    ds_read_b64_tr_b16 v[214:215], v19 offset:3712
    ds_read_b64_tr_b16 v[216:217], v19 offset:160
    ds_read_b64_tr_b16 v[218:219], v19 offset:3744
    ds_read_b64_tr_b16 v[220:221], v20 offset:0
    ds_read_b64_tr_b16 v[222:223], v20 offset:3584
    s_waitcnt lgkmcnt(0)
    ds_write_b128 v21, v[196:199] offset:0
    v_mfma_f32_16x16x32_bf16 v[224:227], v[196:199], v[252:255], 0
    ds_write_b128 v21, v[200:203] offset:1024
    v_mfma_f32_16x16x32_bf16 v[228:231], v[200:203], v[252:255], 0
    ds_write_b128 v21, v[204:207] offset:2048
    v_mfma_f32_16x16x32_bf16 v[232:235], v[204:207], v[252:255], 0
    ds_write_b128 v21, v[208:211] offset:3072
    v_mfma_f32_16x16x32_bf16 v[236:239], v[208:211], v[252:255], 0
    ds_write_b128 v21, v[212:215] offset:4096
    v_mfma_f32_16x16x32_bf16 v[240:243], v[212:215], v[252:255], 0
    ds_write_b128 v21, v[216:219] offset:5120
    v_mfma_f32_16x16x32_bf16 v[244:247], v[216:219], v[252:255], 0
    ds_write_b128 v21, v[220:223] offset:6144
    v_mfma_f32_16x16x32_bf16 v[248:251], v[220:223], v[252:255], 0
    s_waitcnt lgkmcnt(0)
    s_add_u32 s85, 0, s99
    s_lshl_b32 s85, s85, 15
    s_add_u32 s77, s85, 0
    buffer_load_dwordx4 v[32:35], v17, s[36:39], s77 offen
    s_add_u32 s77, s85, 8192
    buffer_load_dwordx4 v[36:39], v17, s[36:39], s77 offen
    s_add_u32 s77, s85, 16384
    buffer_load_dwordx4 v[40:43], v17, s[36:39], s77 offen
    s_add_u32 s77, s85, 24576
    buffer_load_dwordx4 v[44:47], v17, s[36:39], s77 offen
    s_waitcnt vmcnt(20)
    ds_read_b64_tr_b16 v[196:197], v19 offset:28672
    ds_read_b64_tr_b16 v[198:199], v19 offset:32256
    ds_read_b64_tr_b16 v[200:201], v19 offset:28704
    ds_read_b64_tr_b16 v[202:203], v19 offset:32288
    ds_read_b64_tr_b16 v[204:205], v19 offset:28736
    ds_read_b64_tr_b16 v[206:207], v19 offset:32320
    ds_read_b64_tr_b16 v[208:209], v19 offset:28768
    ds_read_b64_tr_b16 v[210:211], v19 offset:32352
    ds_read_b64_tr_b16 v[212:213], v19 offset:28800
    ds_read_b64_tr_b16 v[214:215], v19 offset:32384
    ds_read_b64_tr_b16 v[216:217], v19 offset:28832
    ds_read_b64_tr_b16 v[218:219], v19 offset:32416
    ds_read_b64_tr_b16 v[220:221], v20 offset:28672
    ds_read_b64_tr_b16 v[222:223], v20 offset:32256
    s_waitcnt lgkmcnt(0)
    ds_write_b128 v21, v[196:199] offset:28672
    v_mfma_f32_16x16x32_bf16 v[224:227], v[196:199], v[252:255], v[224:227]
    ds_write_b128 v21, v[200:203] offset:29696
    v_mfma_f32_16x16x32_bf16 v[228:231], v[200:203], v[252:255], v[228:231]
    ds_write_b128 v21, v[204:207] offset:30720
    v_mfma_f32_16x16x32_bf16 v[232:235], v[204:207], v[252:255], v[232:235]
    ds_write_b128 v21, v[208:211] offset:31744
    v_mfma_f32_16x16x32_bf16 v[236:239], v[208:211], v[252:255], v[236:239]
    ds_write_b128 v21, v[212:215] offset:32768
    v_mfma_f32_16x16x32_bf16 v[240:243], v[212:215], v[252:255], v[240:243]
    ds_write_b128 v21, v[216:219] offset:33792
    v_mfma_f32_16x16x32_bf16 v[244:247], v[216:219], v[252:255], v[244:247]
    ds_write_b128 v21, v[220:223] offset:34816
    v_mfma_f32_16x16x32_bf16 v[248:251], v[220:223], v[252:255], v[248:251]
    s_waitcnt lgkmcnt(0)
    s_add_u32 s85, 1, s99
    s_lshl_b32 s85, s85, 15
    s_add_u32 s77, s85, 0
    buffer_load_dwordx4 v[48:51], v17, s[36:39], s77 offen
    s_add_u32 s77, s85, 8192
    buffer_load_dwordx4 v[52:55], v17, s[36:39], s77 offen
    s_add_u32 s77, s85, 16384
    buffer_load_dwordx4 v[56:59], v17, s[36:39], s77 offen
    s_add_u32 s77, s85, 24576
    buffer_load_dwordx4 v[60:63], v17, s[36:39], s77 offen
    s_mov_b32 s79, 0
L_htc_l:
    ds_read_b32 v31, v28 offset:4
    s_add_u32 s79, s79, 1
    s_waitcnt lgkmcnt(0)
    v_readfirstlane_b32 s78, v31
    s_cmp_ge_u32 s79, 0x200000
    s_cbranch_scc1 L_htc_x
    s_cmp_lt_u32 s78, 4
    s_cbranch_scc1 L_htc_l
L_htc_x:
    s_waitcnt vmcnt(16)
    s_mov_b64 exec, s[92:93]
    ds_write_b128 v24, v[132:135] offset:0
    ds_write_b128 v24, v[136:139] offset:896
    ds_write_b128 v24, v[140:143] offset:1792
    ds_write_b128 v24, v[144:147] offset:2688
    ds_write_b128 v24, v[148:151] offset:3584
    ds_write_b128 v24, v[152:155] offset:4480
    ds_write_b128 v24, v[156:159] offset:5376
    ds_write_b128 v24, v[160:163] offset:6272
    s_mov_b64 exec, -1
    s_waitcnt lgkmcnt(0)
    ds_read_b64_tr_b16 v[196:197], v22 offset:0
    ds_read_b64_tr_b16 v[198:199], v22 offset:3584
    ds_read_b64_tr_b16 v[200:201], v22 offset:32
    ds_read_b64_tr_b16 v[202:203], v22 offset:3616
    ds_read_b64_tr_b16 v[204:205], v22 offset:64
    ds_read_b64_tr_b16 v[206:207], v22 offset:3648
    ds_read_b64_tr_b16 v[208:209], v22 offset:96
    ds_read_b64_tr_b16 v[210:211], v22 offset:3680
    ds_read_b64_tr_b16 v[212:213], v22 offset:128
    ds_read_b64_tr_b16 v[214:215], v22 offset:3712
    ds_read_b64_tr_b16 v[216:217], v22 offset:160
    ds_read_b64_tr_b16 v[218:219], v22 offset:3744
    ds_read_b64_tr_b16 v[220:221], v23 offset:0
    ds_read_b64_tr_b16 v[222:223], v23 offset:3584
    s_waitcnt lgkmcnt(0)
    ds_write_b128 v24, v[196:199] offset:0
    v_mfma_f32_16x16x32_bf16 v[224:227], v[196:199], v[252:255], v[224:227]
    ds_write_b128 v24, v[200:203] offset:1024
    v_mfma_f32_16x16x32_bf16 v[228:231], v[200:203], v[252:255], v[228:231]
    ds_write_b128 v24, v[204:207] offset:2048
    v_mfma_f32_16x16x32_bf16 v[232:235], v[204:207], v[252:255], v[232:235]
    ds_write_b128 v24, v[208:211] offset:3072
    v_mfma_f32_16x16x32_bf16 v[236:239], v[208:211], v[252:255], v[236:239]
    ds_write_b128 v24, v[212:215] offset:4096
    v_mfma_f32_16x16x32_bf16 v[240:243], v[212:215], v[252:255], v[240:243]
    ds_write_b128 v24, v[216:219] offset:5120
    v_mfma_f32_16x16x32_bf16 v[244:247], v[216:219], v[252:255], v[244:247]
    ds_write_b128 v24, v[220:223] offset:6144
    v_mfma_f32_16x16x32_bf16 v[248:251], v[220:223], v[252:255], v[248:251]
    s_waitcnt lgkmcnt(0)
    s_waitcnt vmcnt(8)
    s_mov_b64 exec, s[92:93]
    ds_write_b128 v24, v[164:167] offset:28672
    ds_write_b128 v24, v[168:171] offset:29568
    ds_write_b128 v24, v[172:175] offset:30464
    ds_write_b128 v24, v[176:179] offset:31360
    ds_write_b128 v24, v[180:183] offset:32256
    ds_write_b128 v24, v[184:187] offset:33152
    ds_write_b128 v24, v[188:191] offset:34048
    ds_write_b128 v24, v[192:195] offset:34944
    s_mov_b64 exec, -1
    s_waitcnt lgkmcnt(0)
    ds_read_b64_tr_b16 v[196:197], v22 offset:28672
    ds_read_b64_tr_b16 v[198:199], v22 offset:32256
    ds_read_b64_tr_b16 v[200:201], v22 offset:28704
    ds_read_b64_tr_b16 v[202:203], v22 offset:32288
    ds_read_b64_tr_b16 v[204:205], v22 offset:28736
    ds_read_b64_tr_b16 v[206:207], v22 offset:32320
    ds_read_b64_tr_b16 v[208:209], v22 offset:28768
    ds_read_b64_tr_b16 v[210:211], v22 offset:32352
    ds_read_b64_tr_b16 v[212:213], v22 offset:28800
    ds_read_b64_tr_b16 v[214:215], v22 offset:32384
    ds_read_b64_tr_b16 v[216:217], v22 offset:28832
    ds_read_b64_tr_b16 v[218:219], v22 offset:32416
    ds_read_b64_tr_b16 v[220:221], v23 offset:28672
    ds_read_b64_tr_b16 v[222:223], v23 offset:32256
    s_waitcnt lgkmcnt(0)
    ds_write_b128 v24, v[196:199] offset:28672
    v_mfma_f32_16x16x32_bf16 v[224:227], v[196:199], v[252:255], v[224:227]
    ds_write_b128 v24, v[200:203] offset:29696
    v_mfma_f32_16x16x32_bf16 v[228:231], v[200:203], v[252:255], v[228:231]
    ds_write_b128 v24, v[204:207] offset:30720
    v_mfma_f32_16x16x32_bf16 v[232:235], v[204:207], v[252:255], v[232:235]
    ds_write_b128 v24, v[208:211] offset:31744
    v_mfma_f32_16x16x32_bf16 v[236:239], v[208:211], v[252:255], v[236:239]
    ds_write_b128 v24, v[212:215] offset:32768
    v_mfma_f32_16x16x32_bf16 v[240:243], v[212:215], v[252:255], v[240:243]
    ds_write_b128 v24, v[216:219] offset:33792
    v_mfma_f32_16x16x32_bf16 v[244:247], v[216:219], v[252:255], v[244:247]
    ds_write_b128 v24, v[220:223] offset:34816
    v_mfma_f32_16x16x32_bf16 v[248:251], v[220:223], v[252:255], v[248:251]
    s_waitcnt lgkmcnt(0)
    s_nop 3
    s_mov_b32 exec_lo, 0x00010001
    s_mov_b32 exec_hi, 0x00010001
    ds_write_b128 v25, v[224:227] offset:0
    ds_write_b128 v25, v[228:231] offset:64
    ds_write_b128 v25, v[232:235] offset:128
    ds_write_b128 v25, v[236:239] offset:192
    ds_write_b128 v25, v[240:243] offset:256
    ds_write_b128 v25, v[244:247] offset:320
    ds_write_b128 v25, v[248:251] offset:384
    s_mov_b64 exec, -1
    s_waitcnt lgkmcnt(0)
    s_mov_b64 exec, 1
    ds_add_u32 v28, v29 offset:8
    s_mov_b64 exec, -1
    s_add_u32 s85, 4, s99
    s_lshl_b32 s85, s85, 15
    s_add_u32 s77, s85, 0
    buffer_load_dwordx4 v[64:67], v17, s[36:39], s77 offen
    s_add_u32 s77, s85, 8192
    buffer_load_dwordx4 v[68:71], v17, s[36:39], s77 offen
    s_add_u32 s77, s85, 16384
    buffer_load_dwordx4 v[72:75], v17, s[36:39], s77 offen
    s_add_u32 s77, s85, 24576
    buffer_load_dwordx4 v[76:79], v17, s[36:39], s77 offen
    s_add_u32 s85, 5, s99
    s_lshl_b32 s85, s85, 15
    s_add_u32 s77, s85, 0
    buffer_load_dwordx4 v[80:83], v17, s[36:39], s77 offen
    s_add_u32 s77, s85, 8192
    buffer_load_dwordx4 v[84:87], v17, s[36:39], s77 offen
    s_add_u32 s77, s85, 16384
    buffer_load_dwordx4 v[88:91], v17, s[36:39], s77 offen
    s_add_u32 s77, s85, 24576
    buffer_load_dwordx4 v[92:95], v17, s[36:39], s77 offen
    s_sub_u32 s85, 7, s99
    s_lshl_b32 s85, s85, 15
    s_add_u32 s77, s85, 0
    buffer_load_dwordx4 v[96:99], v17, s[36:39], s77 offen
    s_add_u32 s77, s85, 8192
    buffer_load_dwordx4 v[100:103], v17, s[36:39], s77 offen
    s_add_u32 s77, s85, 16384
    buffer_load_dwordx4 v[104:107], v17, s[36:39], s77 offen
    s_add_u32 s77, s85, 24576
    buffer_load_dwordx4 v[108:111], v17, s[36:39], s77 offen
    s_sub_u32 s85, 8, s99
    s_lshl_b32 s85, s85, 15
    s_add_u32 s77, s85, 0
    buffer_load_dwordx4 v[112:115], v17, s[36:39], s77 offen
    s_add_u32 s77, s85, 8192
    buffer_load_dwordx4 v[116:119], v17, s[36:39], s77 offen
    s_add_u32 s77, s85, 16384
    buffer_load_dwordx4 v[120:123], v17, s[36:39], s77 offen
    s_add_u32 s77, s85, 24576
    buffer_load_dwordx4 v[124:127], v17, s[36:39], s77 offen
    s_sub_u32 s85, 11, s99
    s_lshl_b32 s85, s85, 15
    s_add_u32 s77, s85, 0
    buffer_load_dwordx4 v[128:131], v17, s[36:39], s77 offen
    s_add_u32 s77, s85, 8192
    buffer_load_dwordx4 v[132:135], v17, s[36:39], s77 offen
    s_add_u32 s77, s85, 16384
    buffer_load_dwordx4 v[136:139], v17, s[36:39], s77 offen
    s_add_u32 s77, s85, 24576
    buffer_load_dwordx4 v[140:143], v17, s[36:39], s77 offen
    s_sub_u32 s85, 12, s99
    s_lshl_b32 s85, s85, 15
    s_add_u32 s77, s85, 0
    buffer_load_dwordx4 v[144:147], v17, s[36:39], s77 offen
    s_add_u32 s77, s85, 8192
    buffer_load_dwordx4 v[148:151], v17, s[36:39], s77 offen
    s_add_u32 s77, s85, 16384
    buffer_load_dwordx4 v[152:155], v17, s[36:39], s77 offen
    s_add_u32 s77, s85, 24576
    buffer_load_dwordx4 v[156:159], v17, s[36:39], s77 offen
    s_add_u32 s85, 2, s99
    s_lshl_b32 s85, s85, 15
    s_add_u32 s77, s85, 0
    buffer_load_dwordx4 v[160:163], v17, s[36:39], s77 offen
    s_add_u32 s77, s85, 8192
    buffer_load_dwordx4 v[164:167], v17, s[36:39], s77 offen
    s_add_u32 s77, s85, 16384
    buffer_load_dwordx4 v[168:171], v17, s[36:39], s77 offen
    s_add_u32 s77, s85, 24576
    buffer_load_dwordx4 v[172:175], v17, s[36:39], s77 offen
    s_add_u32 s85, 3, s99
    s_lshl_b32 s85, s85, 15
    s_add_u32 s77, s85, 0
    buffer_load_dwordx4 v[176:179], v17, s[36:39], s77 offen
    s_add_u32 s77, s85, 8192
    buffer_load_dwordx4 v[180:183], v17, s[36:39], s77 offen
    s_add_u32 s77, s85, 16384
    buffer_load_dwordx4 v[184:187], v17, s[36:39], s77 offen
    s_add_u32 s77, s85, 24576
    buffer_load_dwordx4 v[188:191], v17, s[36:39], s77 offen
    s_add_u32 s85, 6, s99
    s_lshl_b32 s85, s85, 15
    s_add_u32 s77, s85, 0
    buffer_load_dwordx4 v[192:195], v17, s[36:39], s77 offen
    s_add_u32 s77, s85, 8192
    buffer_load_dwordx4 v[196:199], v17, s[36:39], s77 offen
    s_add_u32 s77, s85, 16384
    buffer_load_dwordx4 v[200:203], v17, s[36:39], s77 offen
    s_add_u32 s77, s85, 24576
    buffer_load_dwordx4 v[204:207], v17, s[36:39], s77 offen
    s_sub_u32 s85, 9, s99
    s_lshl_b32 s85, s85, 15
    s_add_u32 s77, s85, 0
    buffer_load_dwordx4 v[208:211], v17, s[36:39], s77 offen
    s_add_u32 s77, s85, 8192
    buffer_load_dwordx4 v[212:215], v17, s[36:39], s77 offen
    s_add_u32 s77, s85, 16384
    buffer_load_dwordx4 v[216:219], v17, s[36:39], s77 offen
    s_add_u32 s77, s85, 24576
    buffer_load_dwordx4 v[220:223], v17, s[36:39], s77 offen
    s_sub_u32 s85, 10, s99
    s_lshl_b32 s85, s85, 15
    s_add_u32 s77, s85, 0
    buffer_load_dwordx4 v[224:227], v17, s[36:39], s77 offen
    s_add_u32 s77, s85, 8192
    buffer_load_dwordx4 v[228:231], v17, s[36:39], s77 offen
    s_add_u32 s77, s85, 16384
    buffer_load_dwordx4 v[232:235], v17, s[36:39], s77 offen
    s_add_u32 s77, s85, 24576
    buffer_load_dwordx4 v[236:239], v17, s[36:39], s77 offen
    s_sub_u32 s85, 13, s99
    s_lshl_b32 s85, s85, 15
    s_add_u32 s77, s85, 0
    buffer_load_dwordx4 v[240:243], v17, s[36:39], s77 offen
    s_add_u32 s77, s85, 8192
    buffer_load_dwordx4 v[244:247], v17, s[36:39], s77 offen
    s_add_u32 s77, s85, 16384
    buffer_load_dwordx4 v[248:251], v17, s[36:39], s77 offen
    s_add_u32 s77, s85, 24576
    buffer_load_dwordx4 v[252:255], v17, s[36:39], s77 offen
    s_mov_b32 s79, 0
L_hcd_l:
    ds_read_b32 v31, v28 offset:12
    s_add_u32 s79, s79, 1
    s_waitcnt lgkmcnt(0)
    v_readfirstlane_b32 s78, v31
    s_cmp_ge_u32 s79, 0x200000
    s_cbranch_scc1 L_hcd_x
    s_cmp_lt_u32 s78, 4
    s_cbranch_scc1 L_hcd_l
L_hcd_x:
    s_waitcnt vmcnt(52)
    ds_write_b128 v18, v[32:35] offset:0
    ds_write_b128 v18, v[36:39] offset:1024
    ds_write_b128 v18, v[40:43] offset:2048
    ds_write_b128 v18, v[44:47] offset:3072
    s_waitcnt vmcnt(48)
    ds_write_b128 v18, v[48:51] offset:4096
    ds_write_b128 v18, v[52:55] offset:5120
    ds_write_b128 v18, v[56:59] offset:6144
    ds_write_b128 v18, v[60:63] offset:7168
    s_waitcnt vmcnt(44)
    ds_write_b128 v18, v[64:67] offset:8192
    ds_write_b128 v18, v[68:71] offset:9216
    ds_write_b128 v18, v[72:75] offset:10240
    ds_write_b128 v18, v[76:79] offset:11264
    s_waitcnt vmcnt(40)
    ds_write_b128 v18, v[80:83] offset:12288
    ds_write_b128 v18, v[84:87] offset:13312
    ds_write_b128 v18, v[88:91] offset:14336
    ds_write_b128 v18, v[92:95] offset:15360
    s_waitcnt vmcnt(36)
    ds_write_b128 v18, v[96:99] offset:16384
    ds_write_b128 v18, v[100:103] offset:17408
    ds_write_b128 v18, v[104:107] offset:18432
    ds_write_b128 v18, v[108:111] offset:19456
    s_waitcnt vmcnt(32)
    ds_write_b128 v18, v[112:115] offset:20480
    ds_write_b128 v18, v[116:119] offset:21504
    ds_write_b128 v18, v[120:123] offset:22528
    ds_write_b128 v18, v[124:127] offset:23552
    s_waitcnt vmcnt(28)
    ds_write_b128 v18, v[128:131] offset:24576
    ds_write_b128 v18, v[132:135] offset:25600
    ds_write_b128 v18, v[136:139] offset:26624
    ds_write_b128 v18, v[140:143] offset:27648
    s_waitcnt vmcnt(24)
    ds_write_b128 v18, v[144:147] offset:28672
    ds_write_b128 v18, v[148:151] offset:29696
    ds_write_b128 v18, v[152:155] offset:30720
    ds_write_b128 v18, v[156:159] offset:31744
    s_waitcnt vmcnt(20)
    ds_write_b128 v18, v[160:163] offset:32768
    ds_write_b128 v18, v[164:167] offset:33792
    ds_write_b128 v18, v[168:171] offset:34816
    ds_write_b128 v18, v[172:175] offset:35840
    s_waitcnt lgkmcnt(0)
    s_mov_b64 exec, 1
    ds_add_u32 v30, v29 offset:64
    s_mov_b64 exec, -1
    s_cmp_ge_u32 s3, 1
    s_cbranch_scc1 L_hp3_done
    s_lshl_b32 s76, s3, 4
    s_add_u32 s76, s76, s4
    s_add_u32 s76, s76, 80
    s_lshl_b32 s76, s76, 8
    v_mov_b32 v4, s76
    s_mul_i32 s76, s3, 76
    v_add_u32 v5, s76, v28
    s_mov_b64 exec, 1
    s_mov_b32 s76, 0
L_hp3_loop:
    buffer_load_dword v31, v4, s[52:55], 0 offen sc1
    s_add_u32 s76, s76, 1
    s_cmp_ge_u32 s76, 0x40000
    s_cbranch_scc1 L_hp3_exit
    s_waitcnt vmcnt(0)
    v_cmp_gt_u32 vcc, 16, v31
    s_cbranch_vccnz L_hp3_loop
L_hp3_exit:
    s_mov_b64 exec, -1
    s_mov_b64 exec, 1
    ds_add_u32 v5, v29 offset:40
    s_mov_b64 exec, -1
L_hp3_done:
    s_mov_b32 s79, 0
L_hs_l:
    ds_read_b32 v31, v30 offset:80
    s_add_u32 s79, s79, 1
    s_waitcnt lgkmcnt(0)
    v_readfirstlane_b32 s78, v31
    s_cmp_ge_u32 s79, 0x200000
    s_cbranch_scc1 L_hs_x
    s_cmp_lt_u32 s78, 1
    s_cbranch_scc1 L_hs_l
L_hs_x:
    s_waitcnt vmcnt(16)
    ds_write_b128 v18, v[176:179] offset:0
    ds_write_b128 v18, v[180:183] offset:1024
    ds_write_b128 v18, v[184:187] offset:2048
    ds_write_b128 v18, v[188:191] offset:3072
    s_waitcnt vmcnt(12)
    ds_write_b128 v18, v[192:195] offset:4096
    ds_write_b128 v18, v[196:199] offset:5120
    ds_write_b128 v18, v[200:203] offset:6144
    ds_write_b128 v18, v[204:207] offset:7168
    s_waitcnt vmcnt(8)
    ds_write_b128 v18, v[208:211] offset:8192
    ds_write_b128 v18, v[212:215] offset:9216
    ds_write_b128 v18, v[216:219] offset:10240
    ds_write_b128 v18, v[220:223] offset:11264
    s_waitcnt vmcnt(4)
    ds_write_b128 v18, v[224:227] offset:12288
    ds_write_b128 v18, v[228:231] offset:13312
    ds_write_b128 v18, v[232:235] offset:14336
    ds_write_b128 v18, v[236:239] offset:15360
    s_waitcnt vmcnt(0)
    ds_write_b128 v18, v[240:243] offset:16384
    ds_write_b128 v18, v[244:247] offset:17408
    ds_write_b128 v18, v[248:251] offset:18432
    ds_write_b128 v18, v[252:255] offset:19456
    s_waitcnt lgkmcnt(0)
    s_mov_b64 exec, 1
    ds_add_u32 v30, v29 offset:96
    s_mov_b64 exec, -1
L_end:
    s_endpgm
.section .rodata,"a"
.p2align 6
.amdhsa_kernel sequential_preLN__spectral_fnet__dense_activation_relu__prompt_kernel
  .amdhsa_next_free_vgpr 256
  .amdhsa_next_free_sgpr 102
  .amdhsa_accum_offset 256
  .amdhsa_group_segment_fixed_size 0
  .amdhsa_kernarg_size 88
  .amdhsa_user_sgpr_count 2
  .amdhsa_user_sgpr_kernarg_segment_ptr 1
  .amdhsa_system_sgpr_workgroup_id_x 1
.end_amdhsa_kernel
```
